```python
import torch

def _softmax(x, axis=-1):
    return torch.softmax(x, dim=axis)
def _gelu(x):
    return torch.nn.functional.gelu(x, approximate="tanh")
def _silu(x):
    return torch.nn.functional.silu(x)
def _sigmoid(x):
    return torch.sigmoid(x)
def _layernorm(x, axis=-1, eps=1e-5):
    m = x.mean(dim=axis, keepdim=True)
    v = x.var(dim=axis, keepdim=True, unbiased=False)
    return (x - m) / torch.sqrt(v + eps)
def _scatter_add(tgt, idx, src, axis=0):
    return tgt.clone().index_add_(axis, idx, src)
def _segment_sum(src, seg, n):
    out = torch.zeros((n,) + src.shape[1:], dtype=src.dtype)
    return out.index_add_(0, seg, src)
def _pad(x, pw):
    flat = tuple(v for pair in reversed(pw) for v in pair)
    return torch.nn.functional.pad(x, flat)

kernel_name = 'recurrent_scan__compressed_kv_cla__dense_activation_squared_relu__decode'

def setup_inputs():

    _w = (lambda a: (lambda t: t.to(torch.bfloat16) if t.is_floating_point() else t)(torch.as_tensor(a)))
    def _A_setup():
        B, H, Sq, Sk, D, M = 1, 16, 1, 8192, 256, 448
        Dc = 4 * D
        return {
            "x": _w((lambda *s: torch.randn(*s, dtype=torch.bfloat16) * 0.05)(B, Sq, M)),
            "c_kv": _w((lambda *s: torch.randn(*s, dtype=torch.bfloat16) * 0.8)(B, Sk, Dc)),
            "w_q": _w((lambda *s: torch.randn(*s, dtype=torch.bfloat16) * 1.6)(M, H, D) * (M ** -0.5)),
            "w_uk": _w((lambda *s: torch.randn(*s, dtype=torch.bfloat16) * 1.6)(Dc, H, D) * (Dc ** -0.5)),
            "w_uv": _w((lambda *s: torch.randn(*s, dtype=torch.bfloat16) * 0.8)(Dc, H, D) * (Dc ** -0.5)),
            "w_o": _w((lambda *s: torch.randn(*s, dtype=torch.bfloat16) * 0.8)(H, D, M) * ((H * D) ** -0.5)),
        }
    _A_in = _A_setup()

    def _B_setup():
        B, S, D, F = 1, 1, 448, 1792
        return {
            "x": _w((lambda *s: torch.randn(*s, dtype=torch.bfloat16) * 0.05)(B, S, D)),
            "w1": _w((lambda *s: torch.randn(*s, dtype=torch.bfloat16) * 0.2)(D, F)),
            "b1": _w((lambda *s: torch.randn(*s, dtype=torch.bfloat16) * 0.2)(F)),
            "w2": _w((lambda *s: torch.randn(*s, dtype=torch.bfloat16) * 0.2)(F, D)),
            "b2": _w((lambda *s: torch.randn(*s, dtype=torch.bfloat16) * 0.2)(D)),
        }
    _B_in = _B_setup()

    return {
        "A_x": _A_in["x"],
        "A_c_kv": _A_in["c_kv"],
        "A_w_q": _A_in["w_q"],
        "A_w_uk": _A_in["w_uk"],
        "A_w_uv": _A_in["w_uv"],
        "A_w_o": _A_in["w_o"],
        "B_x": _B_in["x"],
        "B_w1": _B_in["w1"],
        "B_b1": _B_in["b1"],
        "B_w2": _B_in["w2"],
        "B_b2": _B_in["b2"],
    }

def reference(A_x, A_c_kv, A_w_q, A_w_uk, A_w_uv, A_w_o, B_x, B_w1, B_b1, B_w2, B_b2):
    def _A_ref(x, c_kv, w_q, w_uk, w_uv, w_o):
        B, Sq, M = x.shape[0], x.shape[1], x.shape[2]
        Sk = c_kv.shape[1]
        H, D = w_q.shape[1], w_q.shape[2]
        q = torch.einsum("bqm,mhd->bhqd", x, w_q)
        k = torch.einsum("bkc,chd->bhkd", c_kv, w_uk)
        v = torch.einsum("bkc,chd->bhkd", c_kv, w_uv)
        scores = torch.einsum("bhqd,bhkd->bhqk", q, k) * (D ** -0.5)
        off = Sk - Sq
        qi = torch.arange(Sq)[:, None]
        kj = torch.arange(Sk)[None, :]
        cmask = kj <= (qi + off)
        scores = torch.where(cmask[None, None], scores, -1e9)
        p = _softmax(scores, axis=-1)
        ctx = torch.einsum("bhqk,bhkd->bhqd", p, v)
        return torch.einsum("bhqd,hdm->bqm", ctx, w_o)

    def _B_ref(x, w1, b1, w2, b2):
        h = torch.einsum("bsd,df->bsf", x, w1) + b1
        zero = torch.zeros_like(h)
        r = torch.where(h > zero, h, zero)
        h = r * r
        out = torch.einsum("bsf,fd->bsd", h, w2) + b2
        return out

    x = A_x
    xn = _layernorm(x, axis=-1)
    s = _A_ref(xn, A_c_kv, A_w_q, A_w_uk, A_w_uv, A_w_o)
    g = _silu(_B_ref(xn, B_w1, B_b1, B_w2, B_b2))
    return x + s * g
```

```asm
; @launch grid=(256,1,1) block=(512,1,1) lds=135168
.amdgcn_target "amdgcn-amd-amdhsa--gfx950"
.text
.globl recurrent_scan__compressed_kv_cla__dense_activation_squared_relu__decode_kernel
.p2align 8
.type recurrent_scan__compressed_kv_cla__dense_activation_squared_relu__decode_kernel,@function
recurrent_scan__compressed_kv_cla__dense_activation_squared_relu__decode_kernel:
    s_cmp_ge_u32 s2, 256
    s_cbranch_scc1 L_end
    s_load_dwordx16 s[8:23], s[0:1], 0
    s_load_dwordx8 s[24:31], s[0:1], 64
    s_load_dwordx4 s[32:35], s[0:1], 96
    s_getreg_b32 s97, hwreg(HW_REG_XCC_ID)
    v_lshrrev_b32 v12, 6, v0
    v_and_b32 v1, 63, v0
    s_and_b32 s4, s2, 7
    v_readfirstlane_b32 s3, v12
    s_lshr_b32 s5, s2, 3
    s_xor_b32 s5, s5, 0
    s_and_b32 s97, s97, 15
    v_and_b32 v2, 15, v1
    v_lshrrev_b32 v3, 4, v1
    v_lshrrev_b32 v5, 3, v1
    v_and_b32 v12, 7, v1
    v_lshlrev_b32 v13, 1, v3
    v_xor_b32 v12, v12, v13
    v_lshlrev_b32 v4, 4, v12
    v_lshlrev_b32 v10, 3, v3
    v_lshrrev_b32 v12, 2, v1
    v_lshlrev_b32 v12, 7, v12
    v_and_b32 v13, 3, v1
    v_lshl_add_u32 v12, v13, 3, v12
    v_and_b32 v13, 3, v5
    v_xor_b32 v14, 0, v13
    v_lshl_add_u32 v6, v14, 5, v12
    v_xor_b32 v14, 1, v13
    v_lshl_add_u32 v7, v14, 5, v12
    v_xor_b32 v14, 2, v13
    v_lshl_add_u32 v8, v14, 5, v12
    v_xor_b32 v14, 3, v13
    v_lshl_add_u32 v9, v14, 5, v12
    s_and_b32 s100, s3, 3
    v_xor_b32 v14, s100, v13
    v_lshl_add_u32 v11, v14, 5, v12
    v_lshlrev_b32 v38, 13, v5
    v_add_u32 v38, v38, v4
    v_lshlrev_b32 v12, 7, v2
    v_and_b32 v13, 1, v3
    v_lshl_add_u32 v12, v13, 4, v12
    v_lshrrev_b32 v13, 1, v2
    v_and_b32 v13, 3, v13
    v_lshrrev_b32 v14, 1, v3
    v_xor_b32 v13, v13, v14
    v_lshl_add_u32 v34, v13, 5, v12
    v_xor_b32 v13, 2, v13
    v_lshl_add_u32 v35, v13, 5, v12
    v_lshlrev_b32 v15, 4, v1
    s_bfe_u32 s6, s5, 0x10003
    s_lshl_b32 s7, s4, 1
    s_add_u32 s6, s6, s7
    s_and_b32 s7, s5, 7
    s_cmp_ge_u32 s5, 16
    s_cbranch_scc1 L_classB
    s_lshl_b32 s101, s3, 13
    s_add_u32 s101, s101, 4096
    v_add_u32 v36, s101, v34
    v_add_u32 v37, s101, v35
    s_lshl_b32 s98, s7, 20
    s_lshr_b32 s100, s3, 2
    s_lshl_b32 s100, s100, 19
    s_add_u32 s98, s98, s100
    s_and_b32 s100, s3, 3
    s_lshl_b32 s100, s100, 16
    s_add_u32 s98, s98, s100
    s_lshl_b32 s100, s6, 9
    s_add_u32 s98, s98, s100
    s_waitcnt lgkmcnt(0)
    s_mov_b64 s[48:49], s[14:15]
    s_mov_b32 s50, 0x800000
    s_mov_b32 s51, 0x20000
    s_mov_b64 s[36:37], s[34:35]
    s_mov_b32 s38, 0x10000000
    s_mov_b32 s39, 0x20000
    s_lshl_b32 s20, s6, 13
    s_lshl_b32 s21, s3, 10
    s_add_u32 s20, s20, s21
    s_add_u32 s20, s20, 786432
    buffer_load_dwordx4 v[16:19], v15, s[36:39], s20 offen sc1

    s_add_u32 s20, s98, 0
    s_add_u32 m0, s101, 0
    s_nop 0
    buffer_load_dwordx4 v38, s[48:51], s20 offen nt lds
    s_add_u32 s20, s98, 128
    s_add_u32 m0, s101, 2048
    s_nop 0
    buffer_load_dwordx4 v38, s[48:51], s20 offen nt lds
    s_add_u32 s20, s98, 256
    s_add_u32 m0, s101, 4096
    s_nop 0
    buffer_load_dwordx4 v38, s[48:51], s20 offen nt lds
    s_add_u32 s20, s98, 384
    s_add_u32 m0, s101, 6144
    s_nop 0
    buffer_load_dwordx4 v38, s[48:51], s20 offen nt lds
    s_add_u32 s20, s98, 262144
    s_add_u32 m0, s101, 1024
    s_nop 0
    buffer_load_dwordx4 v38, s[48:51], s20 offen nt lds
    s_add_u32 s20, s98, 262272
    s_add_u32 m0, s101, 3072
    s_nop 0
    buffer_load_dwordx4 v38, s[48:51], s20 offen nt lds
    s_add_u32 s20, s98, 262400
    s_add_u32 m0, s101, 5120
    s_nop 0
    buffer_load_dwordx4 v38, s[48:51], s20 offen nt lds
    s_add_u32 s20, s98, 262528
    s_add_u32 m0, s101, 7168
    s_nop 0
    buffer_load_dwordx4 v38, s[48:51], s20 offen nt lds
    s_mov_b64 s[40:41], s[8:9]
    s_mov_b32 s42, 0x380
    s_mov_b32 s43, 0x20000
    s_load_dword s99, s[34:35], 0
    s_mul_i32 s33, s7, 6144
    s_lshl_b32 s21, s6, 6
    s_add_u32 s33, s33, s21
    s_add_u32 s33, s33, 262144
    v_lshrrev_b32 v39, 2, v1
    v_lshlrev_b32 v39, 10, v39
    v_and_b32 v12, 3, v1
    v_lshl_add_u32 v39, v12, 4, v39
    s_lshr_b32 s21, s3, 2
    s_mul_i32 s21, s21, 192
    s_and_b32 s32, s3, 3
    s_lshl_b32 s32, s32, 4
    s_add_u32 s21, s21, s32
    v_lshrrev_b32 v32, 1, v3
    v_lshlrev_b32 v32, 6, v32
    v_add_u32 v32, s21, v32
    v_lshlrev_b32 v33, 4, v3
    s_waitcnt lgkmcnt(0)
    s_mul_i32 s96, s99, 0x9E3779B1
    s_add_u32 s96, s96, 0x7F4A7C15
    s_cmp_ge_u32 s3, 2
    s_cbranch_scc1 L_s1_skip
    s_lshl_b32 s20, s6, 13
    s_lshl_b32 s21, s3, 10
    s_add_u32 s20, s20, s21
    s_add_u32 s0, s20, 65536
    s_add_u32 s1, s20, 786432
    s_mov_b32 s20, s1
    s_add_u32 s21, s20, 4096
    s_lshl_b32 s32, s3, 8
    v_lshlrev_b32 v12, 2, v1
    v_add_u32 v12, s32, v12
    s_waitcnt vmcnt(2)
    buffer_load_dwordx4 v[16:19], v15, s[36:39], s20 offen offset:0 sc1
    buffer_load_dwordx4 v[20:23], v15, s[36:39], s20 offen offset:2048 sc1
    buffer_load_dwordx4 v[24:27], v15, s[36:39], s21 offen offset:0 sc1
    buffer_load_dwordx4 v[28:31], v15, s[36:39], s21 offen offset:2048 sc1
    s_waitcnt vmcnt(4)
    ds_read_b128 v[128:131], v36 offset:0
    ds_read_b128 v[132:135], v37 offset:0
    ds_read_b128 v[136:139], v36 offset:2048
    ds_read_b128 v[140:143], v37 offset:2048
    ds_read_b128 v[144:147], v36 offset:4096
    ds_read_b128 v[148:151], v37 offset:4096
    ds_read_b128 v[152:155], v36 offset:6144
    ds_read_b128 v[156:159], v37 offset:6144
    s_waitcnt vmcnt(0)
    v_xor_b32 v13, s96, v17
    v_xor_b32 v14, s96, v19
    v_or_b32 v13, v13, v14
    v_xor_b32 v14, s96, v21
    v_or_b32 v13, v13, v14
    v_xor_b32 v14, s96, v23
    v_or_b32 v13, v13, v14
    v_xor_b32 v14, s96, v25
    v_or_b32 v13, v13, v14
    v_xor_b32 v14, s96, v27
    v_or_b32 v13, v13, v14
    v_xor_b32 v14, s96, v29
    v_or_b32 v13, v13, v14
    v_xor_b32 v14, s96, v31
    v_or_b32 v13, v13, v14
    v_cmp_ne_u32 vcc, 0, v13
    s_cbranch_vccz L_s1_x
    s_mov_b32 s100, 0
L_s1:
    s_and_b32 s21, s100, 33
    s_cmp_eq_u32 s21, 33
    s_cselect_b32 s20, s0, s1
    s_add_u32 s21, s20, 4096
    buffer_load_dwordx4 v[16:19], v15, s[36:39], s20 offen offset:0 sc1
    buffer_load_dwordx4 v[20:23], v15, s[36:39], s20 offen offset:2048 sc1
    buffer_load_dwordx4 v[24:27], v15, s[36:39], s21 offen offset:0 sc1
    buffer_load_dwordx4 v[28:31], v15, s[36:39], s21 offen offset:2048 sc1
    s_waitcnt vmcnt(0)
    v_xor_b32 v13, s96, v17
    v_xor_b32 v14, s96, v19
    v_or_b32 v13, v13, v14
    v_xor_b32 v14, s96, v21
    v_or_b32 v13, v13, v14
    v_xor_b32 v14, s96, v23
    v_or_b32 v13, v13, v14
    v_xor_b32 v14, s96, v25
    v_or_b32 v13, v13, v14
    v_xor_b32 v14, s96, v27
    v_or_b32 v13, v13, v14
    v_xor_b32 v14, s96, v29
    v_or_b32 v13, v13, v14
    v_xor_b32 v14, s96, v31
    v_or_b32 v13, v13, v14
    v_cmp_ne_u32 vcc, 0, v13
    s_add_u32 s100, s100, 1
    s_cmp_gt_u32 s100, 262144
    s_cbranch_scc1 L_s1_x
    s_cbranch_vccnz L_s1

L_s1_x:
    v_add_f32 v16, v16, v20
    v_add_f32 v24, v24, v28
    v_add_f32 v18, v18, v22
    v_add_f32 v26, v26, v30
    v_add_f32 v16, v16, v24
    v_add_f32 v18, v18, v26
    v_cvt_pk_bf16_f32 v16, v16, v18
    ds_write_b32 v12, v16 offset:1024
    s_branch L_s1_done
L_s1_skip:
L_noxtA:
    s_waitcnt vmcnt(0)
    ds_read_b128 v[128:131], v36 offset:0
    ds_read_b128 v[132:135], v37 offset:0
    ds_read_b128 v[136:139], v36 offset:2048
    ds_read_b128 v[140:143], v37 offset:2048
    ds_read_b128 v[144:147], v36 offset:4096
    ds_read_b128 v[148:151], v37 offset:4096
    ds_read_b128 v[152:155], v36 offset:6144
    ds_read_b128 v[156:159], v37 offset:6144
L_s1_done:
    v_mov_b32 v23, s96
    v_mov_b32 v27, s96
    v_mov_b32 v26, 0
    s_waitcnt lgkmcnt(0)
    s_barrier
    ds_read_b128 v[40:43], v33 offset:1024
    ds_read_b128 v[44:47], v33 offset:1088
    ds_read_b128 v[48:51], v33 offset:1152
    ds_read_b128 v[52:55], v33 offset:1216
    ds_read_b128 v[56:59], v33 offset:1280
    ds_read_b128 v[60:63], v33 offset:1344
    ds_read_b128 v[64:67], v33 offset:1408
    ds_read_b128 v[68:71], v33 offset:1472
    s_waitcnt lgkmcnt(7)
    v_mfma_f32_16x16x32_bf16 v[16:19], v[128:131], v[40:43], 0
    s_waitcnt lgkmcnt(6)
    v_mfma_f32_16x16x32_bf16 v[16:19], v[132:135], v[44:47], v[16:19]
    s_waitcnt lgkmcnt(5)
    v_mfma_f32_16x16x32_bf16 v[16:19], v[136:139], v[48:51], v[16:19]
    s_waitcnt lgkmcnt(4)
    v_mfma_f32_16x16x32_bf16 v[16:19], v[140:143], v[52:55], v[16:19]
    s_waitcnt lgkmcnt(3)
    v_mfma_f32_16x16x32_bf16 v[16:19], v[144:147], v[56:59], v[16:19]
    s_waitcnt lgkmcnt(2)
    v_mfma_f32_16x16x32_bf16 v[16:19], v[148:151], v[60:63], v[16:19]
    s_waitcnt lgkmcnt(1)
    v_mfma_f32_16x16x32_bf16 v[16:19], v[152:155], v[64:67], v[16:19]
    s_waitcnt lgkmcnt(0)
    v_mfma_f32_16x16x32_bf16 v[16:19], v[156:159], v[68:71], v[16:19]
    s_nop 7
    v_cvt_pk_bf16_f32 v22, v16, v17
    v_cvt_pk_bf16_f32 v25, v18, v19
    s_nop 1
    v_mov_b32_dpp v20, v22 row_bcast:15 row_mask:0xf bank_mask:0xf
    v_mov_b32_dpp v21, v25 row_bcast:15 row_mask:0xf bank_mask:0xf
    v_mov_b32_dpp v24, v25 row_bcast:31 row_mask:0xf bank_mask:0xf
    s_mov_b32 exec_lo, 0x10000
    s_mov_b32 exec_hi, 0x10000
    ds_write_b128 v32, v[20:23] offset:2560
    s_mov_b32 exec_lo, 0
    ds_write_b128 v32, v[24:27] offset:2624
    s_mov_b64 exec, -1
    s_waitcnt lgkmcnt(0)
    s_barrier
    s_cmp_lg_u32 s3, 0
    s_cbranch_scc1 L_noqa
    ds_read_b128 v[20:23], v15 offset:2560
    s_mov_b64 exec, 0xffffff
    s_waitcnt lgkmcnt(0)
    buffer_store_dwordx4 v[20:23], v39, s[36:39], s33 offen sc1
    s_lshl_b32 s20, s4, 7
    s_lshl_b32 s21, s5, 2
    s_add_u32 s20, s20, s21
    s_add_u32 s20, s20, 4096
    v_mov_b32 v13, 0
    s_mov_b64 exec, 1
    buffer_store_dword v23, v13, s[36:39], s20 offen
    s_mov_b64 exec, -1
L_noqa:
    s_mov_b64 s[52:53], s[22:23]
    s_mov_b32 s54, 0x188000
    s_mov_b32 s55, 0x20000
    s_mov_b64 s[48:49], s[16:17]
    s_mov_b32 s50, 0x800000
    s_mov_b32 s51, 0x20000
    v_mul_u32_u24 v36, 3584, v5
    v_add_u32 v36, v36, v4
    v_mul_u32_u24 v37, 896, v5
    v_add_u32 v37, v37, v4
    v_lshlrev_b32 v28, 3, v1
    v_mov_b32 v25, s96

    s_cmp_lt_u32 s5, 14
    s_cbranch_scc1 L_ffn
    s_lshl_b32 s32, s3, 1
    s_and_b32 s21, s5, 1
    s_add_u32 s32, s32, s21
    s_mul_i32 s0, s32, 3072
    s_add_u32 s0, s0, 262144
    s_lshl_b32 s20, s4, 7
    s_lshl_b32 s21, s32, 2
    s_add_u32 s20, s20, s21
    s_add_u32 s20, s20, 8192
    v_mov_b32 v26, 0
    s_lshl_b32 s1, s4, 7
    s_add_u32 s1, s1, 4096
    v_lshlrev_b32 v13, 2, v2
    s_mov_b32 s100, 0
L_g2:
    buffer_load_dword v14, v13, s[36:39], s1 offen sc1
    s_waitcnt vmcnt(0)
    v_cmp_eq_u32 vcc, s96, v14
    s_add_u32 s100, s100, 1
    s_cmp_gt_u32 s100, 24
    s_cbranch_scc1 L_g2_x
    s_bcnt1_i32_b32 s21, vcc_lo
    s_cmp_ge_u32 s21, 32
    s_cbranch_scc0 L_g2
L_g2_x:

    s_mov_b32 s100, 0
L_fq:
    buffer_load_dwordx4 v[40:43], v15, s[36:39], s0 offen offset:0 sc1
    buffer_load_dwordx4 v[44:47], v15, s[36:39], s0 offen offset:1024 sc1
    buffer_load_dwordx4 v[48:51], v15, s[36:39], s0 offen offset:2048 sc1
    s_waitcnt vmcnt(0)
    v_xor_b32 v13, s96, v43
    v_xor_b32 v14, s96, v47
    v_or_b32 v13, v13, v14
    v_xor_b32 v14, s96, v51
    v_or_b32 v13, v13, v14
    v_cmp_ne_u32 vcc, 0, v13
    s_add_u32 s100, s100, 1
    s_cmp_gt_u32 s100, 262144
    s_cbranch_scc1 L_fq_x
    s_cbranch_vccnz L_fq

L_fq_x:
    s_mov_b64 exec, 1
    buffer_store_dword v25, v26, s[36:39], s20 offen
    s_mov_b64 exec, -1
    s_branch L_ffn_done
L_ffn:
L_ffn_done:
    s_lshl_b32 s26, s6, 3
    s_add_u32 s26, s26, s7
    s_lshl_b32 s26, s26, 11
    s_lshl_b32 s21, s3, 8
    s_add_u32 s26, s26, s21
    s_add_u32 s27, s26, 2359296
    s_add_u32 s26, s26, 2097152
    v_lshlrev_b32 v12, 2, v1
    buffer_load_dword v16, v12, s[36:39], s27 offen
    s_cmp_lg_u32 s3, 6
    s_cbranch_scc1 L_at_x
    s_lshl_b32 s20, s4, 7
    s_add_u32 s20, s20, 16384
    s_lshl_b32 s21, s5, 2
    s_add_u32 s20, s20, s21

    v_mov_b32 v13, 0
    s_mov_b32 s100, 0
L_at:
    buffer_load_dword v14, v13, s[36:39], s20 offen sc1
    s_waitcnt vmcnt(0)
    v_cmp_ne_u32 vcc, s96, v14
    s_add_u32 s100, s100, 1
    s_cmp_gt_u32 s100, 24
    s_cbranch_scc1 L_at_x
    s_cbranch_vccz L_at_x
    s_sleep 2
    s_branch L_at
L_at_x:

    s_barrier
    s_cmp_ge_u32 s5, 14
    s_cbranch_scc1 L_now1
    s_mul_i32 s32, s5, 114688
    s_and_b32 s21, s3, 3
    s_lshl_b32 s33, s21, 10
    s_mul_i32 s21, s21, 28672
    s_add_u32 s32, s32, s21
    s_mul_i32 s21, s4, 448
    s_add_u32 s32, s32, s21
    s_lshr_b32 s21, s3, 2
    s_lshl_b32 s0, s21, 8
    s_add_u32 s32, s32, s0
    s_lshl_b32 s21, s21, 13
    s_add_u32 s33, s33, s21
    s_cmp_lg_u32 s3, 5
    s_cbranch_scc1 L_nox2
    buffer_load_dwordx4 v[16:19], v15, s[40:43], 0 offen
L_nox2:
    s_add_u32 s20, s32, 0
    s_add_u32 m0, s33, 4096
    s_nop 0
    buffer_load_dwordx4 v36, s[52:55], s20 offen nt lds
    s_add_u32 s20, s32, 128
    s_add_u32 m0, s33, 8192
    s_nop 0
    buffer_load_dwordx4 v36, s[52:55], s20 offen nt lds
L_now1:
    s_lshl_b32 s32, s7, 20
    s_lshl_b32 s21, s3, 17
    s_add_u32 s32, s32, s21
    s_lshl_b32 s21, s6, 9
    s_add_u32 s32, s32, s21
    s_lshl_b32 s33, s3, 11
    s_add_u32 s20, s32, 0
    s_add_u32 m0, s33, 20480
    s_nop 0
    buffer_load_dwordx4 v38, s[48:51], s20 offen nt lds
    s_add_u32 s20, s32, 128
    s_add_u32 m0, s33, 36864
    s_nop 0
    buffer_load_dwordx4 v38, s[48:51], s20 offen nt lds
    s_add_u32 s20, s32, 256
    s_add_u32 m0, s33, 53248
    s_nop 0
    buffer_load_dwordx4 v38, s[48:51], s20 offen nt lds
    s_add_u32 s20, s32, 384
    s_add_u32 m0, s33, 69632
    s_nop 0
    buffer_load_dwordx4 v38, s[48:51], s20 offen nt lds
    s_add_u32 s20, s32, 65536
    s_add_u32 m0, s33, 21504
    s_nop 0
    buffer_load_dwordx4 v38, s[48:51], s20 offen nt lds
    s_add_u32 s20, s32, 65664
    s_add_u32 m0, s33, 37888
    s_nop 0
    buffer_load_dwordx4 v38, s[48:51], s20 offen nt lds
    s_add_u32 s20, s32, 65792
    s_add_u32 m0, s33, 54272
    s_nop 0
    buffer_load_dwordx4 v38, s[48:51], s20 offen nt lds
    s_add_u32 s20, s32, 65920
    s_add_u32 m0, s33, 70656
    s_nop 0
    buffer_load_dwordx4 v38, s[48:51], s20 offen nt lds
    s_cmp_ge_u32 s5, 14
    s_cbranch_scc1 L_nof1
    s_cmp_lg_u32 s3, 5
    s_cbranch_scc1 L_nolnA
    s_waitcnt vmcnt(10)
    v_lshlrev_b32 v20, 16, v16
    v_and_b32 v21, 0xffff0000, v16
    v_lshlrev_b32 v22, 16, v17
    v_and_b32 v23, 0xffff0000, v17
    v_lshlrev_b32 v24, 16, v18
    v_and_b32 v25, 0xffff0000, v18
    v_lshlrev_b32 v26, 16, v19
    v_and_b32 v27, 0xffff0000, v19
    v_add_f32 v12, v20, v21
    v_add_f32 v12, v12, v22
    v_add_f32 v12, v12, v23
    v_add_f32 v12, v12, v24
    v_add_f32 v12, v12, v25
    v_add_f32 v12, v12, v26
    v_add_f32 v12, v12, v27
    s_nop 1
    v_add_f32_dpp v12, v12, v12 quad_perm:[1,0,3,2] row_mask:0xf bank_mask:0xf
    s_nop 1
    v_add_f32_dpp v12, v12, v12 quad_perm:[2,3,0,1] row_mask:0xf bank_mask:0xf
    s_nop 1
    v_add_f32_dpp v12, v12, v12 row_half_mirror row_mask:0xf bank_mask:0xf
    s_nop 1
    v_add_f32_dpp v12, v12, v12 row_mirror row_mask:0xf bank_mask:0xf
    s_nop 1
    v_mov_b32 v13, v12
    s_nop 1
    v_permlane16_swap_b32 v12, v13
    s_nop 1
    v_add_f32 v12, v12, v13
    v_mov_b32 v13, v12
    s_nop 1
    v_permlane32_swap_b32 v12, v13
    s_nop 1
    v_add_f32 v12, v12, v13
    v_mul_f32 v12, 0x3b124925, v12
    v_mov_b32 v14, 0
    v_sub_f32 v13, v20, v12
    v_fmac_f32 v14, v13, v13
    v_sub_f32 v13, v21, v12
    v_fmac_f32 v14, v13, v13
    v_sub_f32 v13, v22, v12
    v_fmac_f32 v14, v13, v13
    v_sub_f32 v13, v23, v12
    v_fmac_f32 v14, v13, v13
    v_sub_f32 v13, v24, v12
    v_fmac_f32 v14, v13, v13
    v_sub_f32 v13, v25, v12
    v_fmac_f32 v14, v13, v13
    v_sub_f32 v13, v26, v12
    v_fmac_f32 v14, v13, v13
    v_sub_f32 v13, v27, v12
    v_fmac_f32 v14, v13, v13
    v_cmp_gt_u32 vcc, 56, v1
    s_nop 1
    v_cndmask_b32 v14, 0, v14, vcc
    s_nop 1
    v_add_f32_dpp v14, v14, v14 quad_perm:[1,0,3,2] row_mask:0xf bank_mask:0xf
    s_nop 1
    v_add_f32_dpp v14, v14, v14 quad_perm:[2,3,0,1] row_mask:0xf bank_mask:0xf
    s_nop 1
    v_add_f32_dpp v14, v14, v14 row_half_mirror row_mask:0xf bank_mask:0xf
    s_nop 1
    v_add_f32_dpp v14, v14, v14 row_mirror row_mask:0xf bank_mask:0xf
    s_nop 1
    v_mov_b32 v13, v14
    s_nop 1
    v_permlane16_swap_b32 v14, v13
    s_nop 1
    v_add_f32 v14, v14, v13
    v_mov_b32 v13, v14
    s_nop 1
    v_permlane32_swap_b32 v14, v13
    s_nop 1
    v_add_f32 v14, v14, v13
    v_mul_f32 v14, 0x3b124925, v14
    v_cvt_pk_bf16_f32 v12, v12, v12
    v_lshlrev_b32 v12, 16, v12
    v_cvt_pk_bf16_f32 v14, v14, v14
    v_lshlrev_b32 v14, 16, v14
    v_add_f32 v14, 0x3727c5ac, v14
    v_cvt_pk_bf16_f32 v14, v14, v14
    v_lshlrev_b32 v14, 16, v14
    v_sqrt_f32 v14, v14
    s_nop 0
    v_cvt_pk_bf16_f32 v14, v14, v14
    v_lshlrev_b32 v14, 16, v14
    v_rcp_f32 v14, v14
    s_nop 0
    v_sub_f32 v20, v20, v12
    v_cvt_pk_bf16_f32 v20, v20, v20
    v_lshlrev_b32 v20, 16, v20
    v_mul_f32 v20, v20, v14
    v_sub_f32 v21, v21, v12
    v_cvt_pk_bf16_f32 v21, v21, v21
    v_lshlrev_b32 v21, 16, v21
    v_mul_f32 v21, v21, v14
    v_sub_f32 v22, v22, v12
    v_cvt_pk_bf16_f32 v22, v22, v22
    v_lshlrev_b32 v22, 16, v22
    v_mul_f32 v22, v22, v14
    v_sub_f32 v23, v23, v12
    v_cvt_pk_bf16_f32 v23, v23, v23
    v_lshlrev_b32 v23, 16, v23
    v_mul_f32 v23, v23, v14
    v_sub_f32 v24, v24, v12
    v_cvt_pk_bf16_f32 v24, v24, v24
    v_lshlrev_b32 v24, 16, v24
    v_mul_f32 v24, v24, v14
    v_sub_f32 v25, v25, v12
    v_cvt_pk_bf16_f32 v25, v25, v25
    v_lshlrev_b32 v25, 16, v25
    v_mul_f32 v25, v25, v14
    v_sub_f32 v26, v26, v12
    v_cvt_pk_bf16_f32 v26, v26, v26
    v_lshlrev_b32 v26, 16, v26
    v_mul_f32 v26, v26, v14
    v_sub_f32 v27, v27, v12
    v_cvt_pk_bf16_f32 v27, v27, v27
    v_lshlrev_b32 v27, 16, v27
    v_mul_f32 v27, v27, v14
    v_cvt_pk_bf16_f32 v16, v20, v21
    v_cndmask_b32 v16, 0, v16, vcc
    v_cvt_pk_bf16_f32 v17, v22, v23
    v_cndmask_b32 v17, 0, v17, vcc
    v_cvt_pk_bf16_f32 v18, v24, v25
    v_cndmask_b32 v18, 0, v18, vcc
    v_cvt_pk_bf16_f32 v19, v26, v27
    v_cndmask_b32 v19, 0, v19, vcc
    ds_write_b128 v15, v[16:19] offset:0
    v_mov_b32 v25, s96
L_nolnA:
    s_lshr_b32 s21, s3, 1
    s_lshl_b32 s21, s21, 12
    s_and_b32 s32, s3, 1
    s_cmp_eq_u32 s32, 1
    s_cselect_b64 vcc, -1, 0
    v_cndmask_b32 v12, v6, v8, vcc
    v_cndmask_b32 v13, v7, v9, vcc
    v_add_u32 v12, s21, v12
    v_add_u32 v13, s21, v13
    s_lshl_b32 s21, s5, 6
    v_add_u32 v14, s21, v10
    s_lshl_b32 s20, s4, 4
    s_add_u32 s20, s20, s5
    s_lshl_b32 s20, s20, 11
    s_lshl_b32 s21, s3, 8
    s_add_u32 s20, s20, s21
    s_add_u32 s20, s20, 393216
    v_cmp_lt_u32 vcc, 15, v1
    s_waitcnt vmcnt(8) lgkmcnt(0)
    s_barrier
    ds_read_b64_tr_b16 v[40:41], v12 offset:4096
    ds_read_b64_tr_b16 v[42:43], v12 offset:6144
    ds_read_b64_tr_b16 v[44:45], v13 offset:4096
    ds_read_b64_tr_b16 v[46:47], v13 offset:6144
    ds_read_b64 v[72:73], v14 offset:0
    ds_read_b64 v[74:75], v14 offset:32
    s_waitcnt lgkmcnt(0)
    v_mfma_f32_16x16x32_bf16 v[16:19], v[72:75], v[40:43], 0
    v_mfma_f32_16x16x32_bf16 v[20:23], v[72:75], v[44:47], 0
    s_mov_b32 exec_hi, 0
    s_nop 6
    v_cndmask_b32 v24, v16, v20, vcc
    buffer_store_dwordx2 v[24:25], v28, s[36:39], s20 offen sc1
    s_mov_b64 exec, -1
L_nof1:
    s_lshr_b32 s21, s3, 1
    s_lshl_b32 s21, s21, 14
    s_add_u32 s21, s21, 20480
    s_and_b32 s32, s3, 1
    s_cmp_eq_u32 s32, 1
    s_cselect_b64 vcc, -1, 0
    v_cndmask_b32 v12, v6, v8, vcc
    v_cndmask_b32 v13, v7, v9, vcc
    v_add_u32 v12, s21, v12
    v_add_u32 v13, s21, v13
    s_lshl_b32 s20, s7, 15
    s_lshl_b32 s21, s3, 12
    s_add_u32 s20, s20, s21
    s_lshl_b32 s32, s6, 4
    s_add_u32 s20, s20, s32
    s_add_u32 s20, s20, 1048576
    s_lshl_b32 s32, s6, 3
    s_add_u32 s32, s32, s7
    s_lshl_b32 s32, s32, 15
    s_add_u32 s32, s32, s21
    s_add_u32 s32, s32, 4194304
    v_lshlrev_b32 v14, 8, v3
    s_lshl_b32 s21, s3, 8
    v_lshlrev_b32 v32, 4, v2
    v_lshl_add_u32 v32, v3, 2, v32
    v_add_u32 v32, s21, v32
    s_lshl_b32 s21, s3, 2
    v_mov_b32 v33, s21
    v_and_b32 v34, 7, v2
    v_lshlrev_b32 v34, 8, v34
    v_lshl_add_u32 v34, v3, 4, v34
    v_mov_b32 v35, 0
    s_waitcnt vmcnt(0)
    s_barrier
    ds_read_b64_tr_b16 v[128:129], v12 offset:0
    ds_read_b64_tr_b16 v[130:131], v12 offset:2048
    ds_read_b64_tr_b16 v[132:133], v12 offset:4096
    ds_read_b64_tr_b16 v[134:135], v12 offset:6144
    ds_read_b64_tr_b16 v[136:137], v12 offset:8192
    ds_read_b64_tr_b16 v[138:139], v12 offset:10240
    ds_read_b64_tr_b16 v[140:141], v12 offset:12288
    ds_read_b64_tr_b16 v[142:143], v12 offset:14336
    ds_read_b64_tr_b16 v[144:145], v13 offset:0
    ds_read_b64_tr_b16 v[146:147], v13 offset:2048
    ds_read_b64_tr_b16 v[148:149], v13 offset:4096
    ds_read_b64_tr_b16 v[150:151], v13 offset:6144
    ds_read_b64_tr_b16 v[152:153], v13 offset:8192
    ds_read_b64_tr_b16 v[154:155], v13 offset:10240
    ds_read_b64_tr_b16 v[156:157], v13 offset:12288
    ds_read_b64_tr_b16 v[158:159], v13 offset:14336
    s_lshl_b32 s21, s4, 7
    s_add_u32 s21, s21, 32768
    v_mov_b32 v36, v14
    v_lshlrev_b32 v13, 2, v2
    s_mov_b32 s100, 0
L_gt:
    buffer_load_dword v14, v13, s[36:39], s21 offen sc1
    s_waitcnt vmcnt(0)
    v_cmp_eq_u32 vcc, s96, v14
    s_add_u32 s100, s100, 1
    s_cmp_gt_u32 s100, 32
    s_cbranch_scc1 L_gt_x
    s_bcnt1_i32_b32 s33, vcc_lo
    s_cmp_ge_u32 s33, 26
    s_cbranch_scc1 L_gt_x
    s_sleep 1
    s_branch L_gt
L_gt_x:

    v_mov_b32 v14, v36
    s_mov_b32 s100, 0
L_s3:
    s_sleep 2
    buffer_load_dwordx4 v[16:19], v14, s[36:39], s20 offen offset:0 sc1
    buffer_load_dwordx4 v[20:23], v14, s[36:39], s20 offen offset:1024 sc1
    buffer_load_dwordx4 v[24:27], v14, s[36:39], s20 offen offset:2048 sc1
    buffer_load_dwordx4 v[28:31], v14, s[36:39], s20 offen offset:3072 sc1
    s_waitcnt vmcnt(0)
    v_xor_b32 v12, s96, v18
    v_xor_b32 v13, s96, v19
    v_or_b32 v12, v12, v13
    v_xor_b32 v13, s96, v22
    v_or_b32 v12, v12, v13
    v_xor_b32 v13, s96, v23
    v_or_b32 v12, v12, v13
    v_xor_b32 v13, s96, v26
    v_or_b32 v12, v12, v13
    v_xor_b32 v13, s96, v27
    v_or_b32 v12, v12, v13
    v_xor_b32 v13, s96, v30
    v_or_b32 v12, v12, v13
    v_xor_b32 v13, s96, v31
    v_or_b32 v12, v12, v13
    v_cmp_ne_u32 vcc, 0, v12
    s_add_u32 s100, s100, 1
    s_cmp_gt_u32 s100, 262144
    s_cbranch_scc1 L_s3_x
    s_cbranch_vccnz L_s3

L_s3_x:
    buffer_load_dwordx4 v[72:75], v15, s[36:39], s32 offen offset:0 sc1
    buffer_load_dwordx4 v[76:79], v15, s[36:39], s32 offen offset:1024 sc1
    buffer_load_dwordx4 v[80:83], v15, s[36:39], s32 offen offset:2048 sc1
    buffer_load_dwordx4 v[84:87], v15, s[36:39], s32 offen offset:3072 sc1
L_s3_go:
    v_max3_f32 v18, v16, v20, v24
    v_max_f32 v18, v18, v28
    v_mov_b32 v19, v18
    s_nop 1
    v_permlane16_swap_b32 v18, v19
    s_nop 1
    v_max_f32 v18, v18, v19
    v_mov_b32 v19, v18
    s_nop 1
    v_permlane32_swap_b32 v18, v19
    s_nop 1
    v_max_f32 v18, v18, v19
    v_sub_f32 v16, v16, v18
    v_sub_f32 v20, v20, v18
    v_sub_f32 v24, v24, v18
    v_sub_f32 v28, v28, v18
    v_exp_f32 v16, v16
    v_exp_f32 v20, v20
    v_exp_f32 v24, v24
    v_exp_f32 v28, v28
    s_nop 0
    v_mul_f32 v19, v16, v17
    v_fmac_f32 v19, v20, v21
    v_fmac_f32 v19, v24, v25
    v_fmac_f32 v19, v28, v29
    v_mov_b32 v22, v19
    s_nop 1
    v_permlane16_swap_b32 v19, v22
    s_nop 1
    v_add_f32 v19, v19, v22
    v_mov_b32 v22, v19
    s_nop 1
    v_permlane32_swap_b32 v19, v22
    s_nop 1
    v_add_f32 v19, v19, v22
    v_log_f32 v22, v19
    v_rcp_f32 v19, v19
    s_nop 0
    v_add_f32 v18, v18, v22
    v_mul_f32 v16, v16, v19
    v_mul_f32 v20, v20, v19
    v_mul_f32 v24, v24, v19
    v_mul_f32 v28, v28, v19
    ds_write_b32 v33, v18 offset:1536
    s_waitcnt vmcnt(3)
    v_lshlrev_b32 v22, 16, v72
    v_and_b32 v23, 0xffff0000, v72
    v_mul_f32 v40, v22, v16
    v_mul_f32 v41, v23, v16
    v_lshlrev_b32 v22, 16, v73
    v_and_b32 v23, 0xffff0000, v73
    v_mul_f32 v42, v22, v16
    v_mul_f32 v43, v23, v16
    v_lshlrev_b32 v22, 16, v74
    v_and_b32 v23, 0xffff0000, v74
    v_mul_f32 v44, v22, v16
    v_mul_f32 v45, v23, v16
    v_lshlrev_b32 v22, 16, v75
    v_and_b32 v23, 0xffff0000, v75
    v_mul_f32 v46, v22, v16
    v_mul_f32 v47, v23, v16
    s_waitcnt vmcnt(2)
    v_lshlrev_b32 v22, 16, v76
    v_and_b32 v23, 0xffff0000, v76
    v_fmac_f32 v40, v22, v20
    v_fmac_f32 v41, v23, v20
    v_lshlrev_b32 v22, 16, v77
    v_and_b32 v23, 0xffff0000, v77
    v_fmac_f32 v42, v22, v20
    v_fmac_f32 v43, v23, v20
    v_lshlrev_b32 v22, 16, v78
    v_and_b32 v23, 0xffff0000, v78
    v_fmac_f32 v44, v22, v20
    v_fmac_f32 v45, v23, v20
    v_lshlrev_b32 v22, 16, v79
    v_and_b32 v23, 0xffff0000, v79
    v_fmac_f32 v46, v22, v20
    v_fmac_f32 v47, v23, v20
    s_waitcnt vmcnt(1)
    v_lshlrev_b32 v22, 16, v80
    v_and_b32 v23, 0xffff0000, v80
    v_fmac_f32 v40, v22, v24
    v_fmac_f32 v41, v23, v24
    v_lshlrev_b32 v22, 16, v81
    v_and_b32 v23, 0xffff0000, v81
    v_fmac_f32 v42, v22, v24
    v_fmac_f32 v43, v23, v24
    v_lshlrev_b32 v22, 16, v82
    v_and_b32 v23, 0xffff0000, v82
    v_fmac_f32 v44, v22, v24
    v_fmac_f32 v45, v23, v24
    v_lshlrev_b32 v22, 16, v83
    v_and_b32 v23, 0xffff0000, v83
    v_fmac_f32 v46, v22, v24
    v_fmac_f32 v47, v23, v24
    s_waitcnt vmcnt(0)
    v_lshlrev_b32 v22, 16, v84
    v_and_b32 v23, 0xffff0000, v84
    v_fmac_f32 v40, v22, v28
    v_fmac_f32 v41, v23, v28
    v_lshlrev_b32 v22, 16, v85
    v_and_b32 v23, 0xffff0000, v85
    v_fmac_f32 v42, v22, v28
    v_fmac_f32 v43, v23, v28
    v_lshlrev_b32 v22, 16, v86
    v_and_b32 v23, 0xffff0000, v86
    v_fmac_f32 v44, v22, v28
    v_fmac_f32 v45, v23, v28
    v_lshlrev_b32 v22, 16, v87
    v_and_b32 v23, 0xffff0000, v87
    v_fmac_f32 v46, v22, v28
    v_fmac_f32 v47, v23, v28
    s_nop 1
    v_permlane32_swap_b32 v40, v44
    v_permlane32_swap_b32 v41, v45
    v_permlane32_swap_b32 v42, v46
    v_permlane32_swap_b32 v43, v47
    s_nop 1
    v_add_f32 v40, v40, v44
    v_add_f32 v41, v41, v45
    v_add_f32 v42, v42, v46
    v_add_f32 v43, v43, v47
    s_nop 1
    v_permlane16_swap_b32 v40, v42
    v_permlane16_swap_b32 v41, v43
    s_nop 1
    v_add_f32 v16, v40, v42
    v_add_f32 v17, v41, v43
    v_cvt_pk_bf16_f32 v16, v16, v17
    ds_write_b32 v32, v16 offset:2048
    s_waitcnt lgkmcnt(0)
    s_barrier
    ds_read_b128 v[72:75], v34 offset:2048
    ds_read_b128 v[76:79], v34 offset:2112
    ds_read_b128 v[80:83], v34 offset:2176
    ds_read_b128 v[84:87], v34 offset:2240
    ds_read_b128 v[16:19], v35 offset:1536
    ds_read_b128 v[20:23], v35 offset:1552
    v_lshlrev_b32 v28, 3, v1
    v_mov_b32 v27, s96
    v_and_b32 v24, 1, v3
    v_cmp_eq_u32 vcc, 1, v24
    s_waitcnt lgkmcnt(5)
    v_mfma_f32_16x16x32_bf16 v[40:43], v[72:75], v[128:131], 0
    v_mfma_f32_16x16x32_bf16 v[44:47], v[72:75], v[144:147], 0
    s_waitcnt lgkmcnt(4)
    v_mfma_f32_16x16x32_bf16 v[40:43], v[76:79], v[132:135], v[40:43]
    v_mfma_f32_16x16x32_bf16 v[44:47], v[76:79], v[148:151], v[44:47]
    s_waitcnt lgkmcnt(3)
    v_mfma_f32_16x16x32_bf16 v[40:43], v[80:83], v[136:139], v[40:43]
    v_mfma_f32_16x16x32_bf16 v[44:47], v[80:83], v[152:155], v[44:47]
    s_waitcnt lgkmcnt(2)
    v_mfma_f32_16x16x32_bf16 v[40:43], v[84:87], v[140:143], v[40:43]
    v_mfma_f32_16x16x32_bf16 v[44:47], v[84:87], v[156:159], v[44:47]
    s_waitcnt lgkmcnt(0)
    v_max3_f32 v24, v16, v17, v18
    v_max3_f32 v25, v19, v20, v21
    v_max3_f32 v24, v24, v22, v23
    v_max_f32 v24, v24, v25
    v_sub_f32 v16, v16, v24
    v_sub_f32 v17, v17, v24
    v_sub_f32 v18, v18, v24
    v_sub_f32 v19, v19, v24
    v_sub_f32 v20, v20, v24
    v_sub_f32 v21, v21, v24
    v_sub_f32 v22, v22, v24
    v_sub_f32 v23, v23, v24
    v_exp_f32 v16, v16
    v_exp_f32 v17, v17
    v_exp_f32 v18, v18
    v_exp_f32 v19, v19
    v_exp_f32 v20, v20
    v_exp_f32 v21, v21
    v_exp_f32 v22, v22
    v_exp_f32 v23, v23
    s_nop 0
    v_add_f32 v24, v16, v17
    v_add_f32 v25, v18, v19
    v_add_f32 v26, v20, v21
    v_add_f32 v29, v22, v23
    v_add_f32 v24, v24, v25
    v_add_f32 v26, v26, v29
    v_add_f32 v24, v24, v26
    v_rcp_f32 v24, v24
    v_cndmask_b32 v16, v16, v20, vcc
    v_cndmask_b32 v17, v17, v21, vcc
    v_cndmask_b32 v18, v18, v22, vcc
    v_cndmask_b32 v19, v19, v23, vcc
    v_mul_f32 v20, v16, v40
    v_fmac_f32 v20, v17, v41
    v_fmac_f32 v20, v18, v42
    v_fmac_f32 v20, v19, v43
    v_mul_f32 v21, v16, v44
    v_fmac_f32 v21, v17, v45
    v_fmac_f32 v21, v18, v46
    v_fmac_f32 v21, v19, v47
    s_nop 1
    v_permlane16_swap_b32 v20, v21
    s_mov_b32 exec_hi, 0
    v_add_f32 v26, v20, v21
    v_mul_f32 v26, v26, v24
    buffer_store_dwordx2 v[26:27], v28, s[36:39], s27 offen
    buffer_store_dwordx2 v[26:27], v28, s[36:39], s26 offen sc1
    s_mov_b64 exec, -1
    s_cmp_lg_u32 s3, 3
    s_cbranch_scc1 L_noep
    s_or_b32 s20, s5, s4
    s_cmp_lg_u32 s20, 0
    s_cbranch_scc1 L_noep
    s_add_u32 s20, s99, 1
    v_mov_b32 v13, s20
    v_mov_b32 v14, 0
    s_mov_b64 exec, 1
    buffer_store_dword v13, v14, s[36:39], 0 offen sc1
    s_mov_b64 exec, -1
L_noep:
    s_endpgm
L_classB:
    s_lshr_b32 s98, s7, 2
    s_lshl_b32 s98, s98, 21
    s_lshl_b32 s100, s3, 18
    s_add_u32 s98, s98, s100
    s_lshl_b32 s100, s6, 9
    s_add_u32 s98, s98, s100
    s_and_b32 s100, s7, 3
    s_lshl_b32 s100, s100, 7
    s_add_u32 s98, s98, s100
    s_lshl_b32 s101, s3, 14
    s_add_u32 s101, s101, 4096
    v_lshlrev_b32 v39, 11, v5
    v_add_u32 v39, v39, v4
    s_sub_u32 s61, s5, 16
    s_lshl_b32 s60, s4, 4
    s_add_u32 s60, s60, s61
    s_lshl_b32 s60, s60, 17
    s_lshl_b32 s100, s3, 8
    s_add_u32 s60, s60, s100
    s_waitcnt lgkmcnt(0)
    s_mov_b64 s[40:41], s[8:9]
    s_mov_b32 s42, 0x380
    s_mov_b32 s43, 0x20000
    s_mov_b64 s[44:45], s[12:13]
    s_mov_b32 s46, 0x380000
    s_mov_b32 s47, 0x20000
    s_cmp_lg_u32 s3, 0
    s_cbranch_scc1 L_nox
    buffer_load_dwordx4 v[16:19], v15, s[40:43], 0 offen
L_nox:
    s_add_u32 s20, s98, 0
    s_add_u32 m0, s101, 12288
    s_nop 0
    buffer_load_dwordx4 v38, s[44:47], s20 offen nt lds
    s_add_u32 s20, s98, 65536
    s_add_u32 m0, s101, 13312
    s_nop 0
    buffer_load_dwordx4 v38, s[44:47], s20 offen nt lds
    s_add_u32 s20, s98, 131072
    s_add_u32 m0, s101, 14336
    s_nop 0
    buffer_load_dwordx4 v38, s[44:47], s20 offen nt lds
    s_add_u32 s20, s98, 196608
    s_add_u32 m0, s101, 15360
    s_nop 0
    buffer_load_dwordx4 v38, s[44:47], s20 offen nt lds
    s_mov_b64 s[48:49], s[10:11]
    s_mov_b32 s50, 0x1000000
    s_mov_b32 s51, 0x20000
    s_mov_b64 s[36:37], s[34:35]
    s_mov_b32 s38, 0x10000000
    s_mov_b32 s39, 0x20000
    s_load_dword s99, s[34:35], 0
    v_mov_b32 v38, v39
    s_barrier
    s_add_u32 s20, s60, 0
    s_add_u32 m0, s101, 0
    s_nop 0
    buffer_load_dwordx4 v38, s[48:51], s20 offen nt lds
    s_add_u32 s20, s60, 128
    s_add_u32 m0, s101, 2048
    s_nop 0
    buffer_load_dwordx4 v38, s[48:51], s20 offen nt lds
    s_cmp_lg_u32 s3, 0
    s_cbranch_scc1 L_noln
    s_waitcnt vmcnt(6)
    v_lshlrev_b32 v20, 16, v16
    v_and_b32 v21, 0xffff0000, v16
    v_lshlrev_b32 v22, 16, v17
    v_and_b32 v23, 0xffff0000, v17
    v_lshlrev_b32 v24, 16, v18
    v_and_b32 v25, 0xffff0000, v18
    v_lshlrev_b32 v26, 16, v19
    v_and_b32 v27, 0xffff0000, v19
    v_add_f32 v12, v20, v21
    v_add_f32 v12, v12, v22
    v_add_f32 v12, v12, v23
    v_add_f32 v12, v12, v24
    v_add_f32 v12, v12, v25
    v_add_f32 v12, v12, v26
    v_add_f32 v12, v12, v27
    s_nop 1
    v_add_f32_dpp v12, v12, v12 quad_perm:[1,0,3,2] row_mask:0xf bank_mask:0xf
    s_nop 1
    v_add_f32_dpp v12, v12, v12 quad_perm:[2,3,0,1] row_mask:0xf bank_mask:0xf
    s_nop 1
    v_add_f32_dpp v12, v12, v12 row_half_mirror row_mask:0xf bank_mask:0xf
    s_nop 1
    v_add_f32_dpp v12, v12, v12 row_mirror row_mask:0xf bank_mask:0xf
    s_nop 1
    v_mov_b32 v13, v12
    s_nop 1
    v_permlane16_swap_b32 v12, v13
    s_nop 1
    v_add_f32 v12, v12, v13
    v_mov_b32 v13, v12
    s_nop 1
    v_permlane32_swap_b32 v12, v13
    s_nop 1
    v_add_f32 v12, v12, v13
    v_mul_f32 v12, 0x3b124925, v12
    v_mov_b32 v14, 0
    v_sub_f32 v13, v20, v12
    v_fmac_f32 v14, v13, v13
    v_sub_f32 v13, v21, v12
    v_fmac_f32 v14, v13, v13
    v_sub_f32 v13, v22, v12
    v_fmac_f32 v14, v13, v13
    v_sub_f32 v13, v23, v12
    v_fmac_f32 v14, v13, v13
    v_sub_f32 v13, v24, v12
    v_fmac_f32 v14, v13, v13
    v_sub_f32 v13, v25, v12
    v_fmac_f32 v14, v13, v13
    v_sub_f32 v13, v26, v12
    v_fmac_f32 v14, v13, v13
    v_sub_f32 v13, v27, v12
    v_fmac_f32 v14, v13, v13
    v_cmp_gt_u32 vcc, 56, v1
    s_nop 1
    v_cndmask_b32 v14, 0, v14, vcc
    s_nop 1
    v_add_f32_dpp v14, v14, v14 quad_perm:[1,0,3,2] row_mask:0xf bank_mask:0xf
    s_nop 1
    v_add_f32_dpp v14, v14, v14 quad_perm:[2,3,0,1] row_mask:0xf bank_mask:0xf
    s_nop 1
    v_add_f32_dpp v14, v14, v14 row_half_mirror row_mask:0xf bank_mask:0xf
    s_nop 1
    v_add_f32_dpp v14, v14, v14 row_mirror row_mask:0xf bank_mask:0xf
    s_nop 1
    v_mov_b32 v13, v14
    s_nop 1
    v_permlane16_swap_b32 v14, v13
    s_nop 1
    v_add_f32 v14, v14, v13
    v_mov_b32 v13, v14
    s_nop 1
    v_permlane32_swap_b32 v14, v13
    s_nop 1
    v_add_f32 v14, v14, v13
    v_mul_f32 v14, 0x3b124925, v14
    v_cvt_pk_bf16_f32 v12, v12, v12
    v_lshlrev_b32 v12, 16, v12
    v_cvt_pk_bf16_f32 v14, v14, v14
    v_lshlrev_b32 v14, 16, v14
    v_add_f32 v14, 0x3727c5ac, v14
    v_cvt_pk_bf16_f32 v14, v14, v14
    v_lshlrev_b32 v14, 16, v14
    v_sqrt_f32 v14, v14
    s_nop 0
    v_cvt_pk_bf16_f32 v14, v14, v14
    v_lshlrev_b32 v14, 16, v14
    v_rcp_f32 v14, v14
    s_nop 0
    v_sub_f32 v20, v20, v12
    v_cvt_pk_bf16_f32 v20, v20, v20
    v_lshlrev_b32 v20, 16, v20
    v_mul_f32 v20, v20, v14
    v_sub_f32 v21, v21, v12
    v_cvt_pk_bf16_f32 v21, v21, v21
    v_lshlrev_b32 v21, 16, v21
    v_mul_f32 v21, v21, v14
    v_sub_f32 v22, v22, v12
    v_cvt_pk_bf16_f32 v22, v22, v22
    v_lshlrev_b32 v22, 16, v22
    v_mul_f32 v22, v22, v14
    v_sub_f32 v23, v23, v12
    v_cvt_pk_bf16_f32 v23, v23, v23
    v_lshlrev_b32 v23, 16, v23
    v_mul_f32 v23, v23, v14
    v_sub_f32 v24, v24, v12
    v_cvt_pk_bf16_f32 v24, v24, v24
    v_lshlrev_b32 v24, 16, v24
    v_mul_f32 v24, v24, v14
    v_sub_f32 v25, v25, v12
    v_cvt_pk_bf16_f32 v25, v25, v25
    v_lshlrev_b32 v25, 16, v25
    v_mul_f32 v25, v25, v14
    v_sub_f32 v26, v26, v12
    v_cvt_pk_bf16_f32 v26, v26, v26
    v_lshlrev_b32 v26, 16, v26
    v_mul_f32 v26, v26, v14
    v_sub_f32 v27, v27, v12
    v_cvt_pk_bf16_f32 v27, v27, v27
    v_lshlrev_b32 v27, 16, v27
    v_mul_f32 v27, v27, v14
    v_cvt_pk_bf16_f32 v16, v20, v21
    v_cndmask_b32 v16, 0, v16, vcc
    v_cvt_pk_bf16_f32 v17, v22, v23
    v_cndmask_b32 v17, 0, v17, vcc
    v_cvt_pk_bf16_f32 v18, v24, v25
    v_cndmask_b32 v18, 0, v18, vcc
    v_cvt_pk_bf16_f32 v19, v26, v27
    v_cndmask_b32 v19, 0, v19, vcc
    ds_write_b128 v15, v[16:19] offset:0
L_noln:
    s_lshr_b32 s21, s7, 2
    s_lshl_b32 s21, s21, 1
    s_lshr_b32 s32, s3, 2
    s_add_u32 s21, s21, s32
    s_lshl_b32 s33, s21, 8
    v_add_u32 v13, s33, v10
    s_lshl_b32 s32, s32, 16
    s_add_u32 s32, s32, 16384
    v_add_u32 v14, s32, v11
    s_lshl_b32 s20, s6, 13
    s_lshl_b32 s21, s21, 11
    s_add_u32 s20, s20, s21
    s_and_b32 s21, s7, 3
    s_lshl_b32 s21, s21, 9
    s_add_u32 s20, s20, s21
    s_and_b32 s21, s3, 3
    s_lshl_b32 s21, s21, 7
    s_add_u32 s20, s20, s21
    s_add_u32 s20, s20, 65536
    s_add_u32 s21, s20, 720896
    v_lshlrev_b32 v12, 3, v2
    s_waitcnt vmcnt(2) lgkmcnt(0)
    s_mul_i32 s96, s99, 0x9E3779B1
    s_add_u32 s96, s96, 0x7F4A7C15
    v_mov_b32 v21, s96
    v_mov_b32 v22, 0
    ds_write_b32 v22, v22 offset:1024
    s_waitcnt lgkmcnt(0)
    s_barrier
    ds_read_b64_tr_b16 v[40:41], v14 offset:0
    ds_read_b64_tr_b16 v[42:43], v14 offset:2048
    ds_read_b64 v[72:73], v13 offset:0
    ds_read_b64 v[74:75], v13 offset:32
    ds_read_b64_tr_b16 v[44:45], v14 offset:16384
    ds_read_b64_tr_b16 v[46:47], v14 offset:18432
    ds_read_b64 v[76:77], v13 offset:64
    ds_read_b64 v[78:79], v13 offset:96
    ds_read_b64_tr_b16 v[48:49], v14 offset:32768
    ds_read_b64_tr_b16 v[50:51], v14 offset:34816
    ds_read_b64 v[80:81], v13 offset:128
    ds_read_b64 v[82:83], v13 offset:160
    ds_read_b64_tr_b16 v[52:53], v14 offset:49152
    ds_read_b64_tr_b16 v[54:55], v14 offset:51200
    ds_read_b64 v[84:85], v13 offset:192
    ds_read_b64 v[86:87], v13 offset:224
    s_waitcnt lgkmcnt(12)
    v_mfma_f32_16x16x32_bf16 v[16:19], v[72:75], v[40:43], 0
    s_waitcnt lgkmcnt(8)
    v_mfma_f32_16x16x32_bf16 v[16:19], v[76:79], v[44:47], v[16:19]
    s_waitcnt lgkmcnt(4)
    v_mfma_f32_16x16x32_bf16 v[16:19], v[80:83], v[48:51], v[16:19]
    s_waitcnt lgkmcnt(0)
    v_mfma_f32_16x16x32_bf16 v[16:19], v[84:87], v[52:55], v[16:19]
    s_mov_b64 exec, 0xffff
    s_nop 6
    v_mov_b32 v20, v16
    buffer_store_dwordx2 v[20:21], v12, s[36:39], s21 offen
    buffer_store_dwordx2 v[20:21], v12, s[36:39], s20 offen sc1
    s_mov_b64 exec, -1
    s_mov_b32 s7, s61
    s_lshl_b32 s20, s4, 3
    s_lshr_b32 s21, s7, 1
    s_add_u32 s20, s20, s21
    s_lshl_b32 s20, s20, 7
    s_add_u32 s20, s20, 40960
    v_mov_b32 v13, 0
    s_cmp_lg_u32 s3, 3
    s_cbranch_scc1 L_noptr
    buffer_load_dword v16, v13, s[36:39], s20 offen sc1
    s_lshl_b32 s20, s4, 7
    s_add_u32 s20, s20, 8192
    buffer_load_dword v17, v13, s[36:39], s20 offen sc1
L_noptr:

    s_barrier
    s_add_u32 s20, s60, 16384
    s_add_u32 m0, s101, 1024
    s_nop 0
    buffer_load_dwordx4 v38, s[48:51], s20 offen nt lds
    s_add_u32 s20, s60, 16512
    s_add_u32 m0, s101, 3072
    s_nop 0
    buffer_load_dwordx4 v38, s[48:51], s20 offen nt lds
    s_add_u32 s20, s60, 32768
    s_add_u32 m0, s101, 4096
    s_nop 0
    buffer_load_dwordx4 v38, s[48:51], s20 offen nt lds
    s_add_u32 s20, s60, 32896
    s_add_u32 m0, s101, 6144
    s_nop 0
    buffer_load_dwordx4 v38, s[48:51], s20 offen nt lds
    s_add_u32 s20, s60, 49152
    s_add_u32 m0, s101, 5120
    s_nop 0
    buffer_load_dwordx4 v38, s[48:51], s20 offen nt lds
    s_add_u32 s20, s60, 49280
    s_add_u32 m0, s101, 7168
    s_nop 0
    buffer_load_dwordx4 v38, s[48:51], s20 offen nt lds
    s_add_u32 s20, s60, 65536
    s_add_u32 m0, s101, 8192
    s_nop 0
    buffer_load_dwordx4 v38, s[48:51], s20 offen nt lds
    s_add_u32 s20, s60, 65664
    s_add_u32 m0, s101, 10240
    s_nop 0
    buffer_load_dwordx4 v38, s[48:51], s20 offen nt lds
    s_add_u32 s20, s60, 81920
    s_add_u32 m0, s101, 9216
    s_nop 0
    buffer_load_dwordx4 v38, s[48:51], s20 offen nt lds
    s_add_u32 s20, s60, 82048
    s_add_u32 m0, s101, 11264
    s_nop 0
    buffer_load_dwordx4 v38, s[48:51], s20 offen nt lds
    s_add_u32 s20, s60, 98304
    s_add_u32 m0, s101, 12288
    s_nop 0
    buffer_load_dwordx4 v38, s[48:51], s20 offen nt lds
    s_add_u32 s20, s60, 98432
    s_add_u32 m0, s101, 14336
    s_nop 0
    buffer_load_dwordx4 v38, s[48:51], s20 offen nt lds
    s_add_u32 s20, s60, 114688
    s_add_u32 m0, s101, 13312
    s_nop 0
    buffer_load_dwordx4 v38, s[48:51], s20 offen nt lds
    s_add_u32 s20, s60, 114816
    s_add_u32 m0, s101, 15360
    s_nop 0
    buffer_load_dwordx4 v38, s[48:51], s20 offen nt lds
    v_add_u32 v36, s101, v34
    v_add_u32 v37, s101, v35
    v_add_u32 v32, s101, v6
    v_add_u32 v33, s101, v7
    v_add_u32 v34, s101, v8
    v_add_u32 v35, s101, v9
    v_lshlrev_b32 v12, 6, v2
    v_lshl_add_u32 v39, v3, 4, v12
    s_mul_i32 s0, s3, 6144
    s_add_u32 s0, s0, 262144
    s_add_u32 s1, s0, 3072
    v_lshlrev_b32 v30, 4, v1
    v_add_u32 v31, s101, v30
    s_lshl_b32 s61, s4, 7
    s_add_u32 s61, s61, 8192
    s_lshl_b32 s33, s3, 1
    s_lshl_b32 s63, 3, s33
    v_lshlrev_b32 v27, 2, v2
    v_and_b32 v12, 3, v2
    v_xor_b32 v12, v12, v3
    v_lshlrev_b32 v12, 4, v12
    v_lshl_add_u32 v12, v2, 8, v12
    v_add_u32 v12, s101, v12
    v_lshrrev_b32 v13, 2, v2
    v_lshl_add_u32 v216, v13, 6, v12
    v_xor_b32 v14, 1, v13
    v_lshl_add_u32 v217, v14, 6, v12
    v_xor_b32 v14, 2, v13
    v_lshl_add_u32 v218, v14, 6, v12
    v_xor_b32 v14, 3, v13
    v_lshl_add_u32 v219, v14, 6, v12
    s_lshl_b32 s33, s3, 1
    v_and_b32 v12, 1, v3
    v_add_u32 v12, s33, v12
    v_xor_b32 v13, v2, v12
    v_lshlrev_b32 v13, 4, v13
    v_lshl_add_u32 v13, v12, 8, v13
    v_lshrrev_b32 v14, 5, v1
    v_lshl_add_u32 v13, v14, 16, v13
    v_add_u32 v220, 4096, v13
    v_lshrrev_b32 v13, 3, v2
    v_lshlrev_b32 v13, 10, v13
    v_and_b32 v221, 3, v2
    v_lshl_add_u32 v13, v221, 8, v13
    v_lshl_add_u32 v13, v12, 4, v13
    v_bfe_u32 v221, v2, 2, 1
    v_lshl_add_u32 v13, v221, 3, v13
    v_lshl_add_u32 v221, v14, 2, v13
    v_lshlrev_b32 v222, 3, v12
    v_lshlrev_b32 v223, 3, v2
    v_sub_u32 v12, v3, v2
    v_lshlrev_b32 v12, 8, v12
    v_add_u32 v224, v216, v12
    v_add_u32 v225, v217, v12
    v_add_u32 v226, v218, v12
    v_add_u32 v227, v219, v12
    s_movk_i32 s33, 0x78
    v_lshlrev_b32 v12, 1, v3
    v_lshrrev_b32 v12, v12, s33
    v_and_b32 v12, 3, v12
    v_xor_b32 v12, v12, v1
    v_lshlrev_b32 v229, 4, v12
    v_lshrrev_b32 v12, 2, v2
    v_lshlrev_b32 v12, 1, v12
    v_lshrrev_b32 v12, v12, s33
    v_and_b32 v12, 3, v12
    v_xor_b32 v12, v12, v3
    v_lshl_add_u32 v12, v2, 2, v12
    v_lshlrev_b32 v12, 4, v12
    v_add_u32 v230, s101, v12
    v_lshlrev_b32 v228, 18, v3
    v_lshl_add_u32 v228, v2, 4, v228
    s_waitcnt vmcnt(12)
    ds_read_b128 v[40:43], v36 offset:0
    ds_read_b128 v[44:47], v37 offset:0
    ds_read_b128 v[48:51], v36 offset:2048
    ds_read_b128 v[52:55], v37 offset:2048
    ds_read_b64_tr_b16 v[104:105], v32 offset:0
    ds_read_b64_tr_b16 v[112:113], v33 offset:0
    ds_read_b64_tr_b16 v[120:121], v34 offset:0
    ds_read_b64_tr_b16 v[128:129], v35 offset:0
    ds_read_b64_tr_b16 v[136:137], v32 offset:2048
    ds_read_b64_tr_b16 v[144:145], v33 offset:2048
    ds_read_b64_tr_b16 v[152:153], v34 offset:2048
    ds_read_b64_tr_b16 v[160:161], v35 offset:2048
    s_waitcnt vmcnt(8)
    s_cmp_lg_u32 s3, 7
    s_cbranch_scc1 L_nobsig
    s_lshl_b32 s20, s4, 7
    s_lshl_b32 s21, s7, 2
    s_add_u32 s20, s20, s21
    s_add_u32 s20, s20, 16384
    v_mov_b32 v12, s96
    v_mov_b32 v13, 0
    s_mov_b64 exec, 1
    buffer_store_dword v12, v13, s[36:39], s20 offen
    s_mov_b64 exec, -1
L_nobsig:

    ds_read_b128 v[56:59], v36 offset:4096
    ds_read_b128 v[60:63], v37 offset:4096
    ds_read_b128 v[64:67], v36 offset:6144
    ds_read_b128 v[68:71], v37 offset:6144
    ds_read_b64_tr_b16 v[106:107], v32 offset:4096
    ds_read_b64_tr_b16 v[114:115], v33 offset:4096
    ds_read_b64_tr_b16 v[122:123], v34 offset:4096
    ds_read_b64_tr_b16 v[130:131], v35 offset:4096
    ds_read_b64_tr_b16 v[138:139], v32 offset:6144
    ds_read_b64_tr_b16 v[146:147], v33 offset:6144
    ds_read_b64_tr_b16 v[154:155], v34 offset:6144
    ds_read_b64_tr_b16 v[162:163], v35 offset:6144
    s_waitcnt vmcnt(4)
    ds_read_b128 v[72:75], v36 offset:8192
    ds_read_b128 v[76:79], v37 offset:8192
    ds_read_b128 v[80:83], v36 offset:10240
    ds_read_b128 v[84:87], v37 offset:10240
    ds_read_b64_tr_b16 v[108:109], v32 offset:8192
    ds_read_b64_tr_b16 v[116:117], v33 offset:8192
    ds_read_b64_tr_b16 v[124:125], v34 offset:8192
    ds_read_b64_tr_b16 v[132:133], v35 offset:8192
    ds_read_b64_tr_b16 v[140:141], v32 offset:10240
    ds_read_b64_tr_b16 v[148:149], v33 offset:10240
    ds_read_b64_tr_b16 v[156:157], v34 offset:10240
    ds_read_b64_tr_b16 v[164:165], v35 offset:10240
    s_waitcnt vmcnt(3)
    v_mov_b32 v13, 0
    ds_read_b32 v26, v13 offset:1024
    s_waitcnt lgkmcnt(0)
    v_cmp_ne_u32 vcc, s96, v26
    s_cbranch_vccnz L_nohint
    buffer_load_dwordx4 v[168:171], v39, s[36:39], s0 offen offset:0 sc1
    buffer_load_dwordx4 v[172:175], v39, s[36:39], s0 offen offset:1024 sc1
    buffer_load_dwordx4 v[176:179], v39, s[36:39], s0 offen offset:2048 sc1
    buffer_load_dwordx4 v[180:183], v39, s[36:39], s1 offen offset:0 sc1
    buffer_load_dwordx4 v[184:187], v39, s[36:39], s1 offen offset:1024 sc1
    buffer_load_dwordx4 v[188:191], v39, s[36:39], s1 offen offset:2048 sc1
    s_waitcnt vmcnt(6)
    ds_read_b128 v[88:91], v36 offset:12288
    ds_read_b128 v[92:95], v37 offset:12288
    ds_read_b128 v[96:99], v36 offset:14336
    ds_read_b128 v[100:103], v37 offset:14336
    ds_read_b64_tr_b16 v[110:111], v32 offset:12288
    ds_read_b64_tr_b16 v[118:119], v33 offset:12288
    ds_read_b64_tr_b16 v[126:127], v34 offset:12288
    ds_read_b64_tr_b16 v[134:135], v35 offset:12288
    ds_read_b64_tr_b16 v[142:143], v32 offset:14336
    ds_read_b64_tr_b16 v[150:151], v33 offset:14336
    ds_read_b64_tr_b16 v[158:159], v34 offset:14336
    ds_read_b64_tr_b16 v[166:167], v35 offset:14336
    s_waitcnt vmcnt(0)
    s_branch L_qgot
L_nohint:
    buffer_load_dword v26, v27, s[36:39], s61 offen sc1
    s_waitcnt vmcnt(0)
    v_cmp_ne_u32 vcc, s96, v26
    s_and_b32 s20, vcc_lo, s63
    s_cbranch_scc1 L_notyet
    buffer_load_dwordx4 v[168:171], v39, s[36:39], s0 offen offset:0 sc1
    buffer_load_dwordx4 v[172:175], v39, s[36:39], s0 offen offset:1024 sc1
    buffer_load_dwordx4 v[176:179], v39, s[36:39], s0 offen offset:2048 sc1
    buffer_load_dwordx4 v[180:183], v39, s[36:39], s1 offen offset:0 sc1
    buffer_load_dwordx4 v[184:187], v39, s[36:39], s1 offen offset:1024 sc1
    buffer_load_dwordx4 v[188:191], v39, s[36:39], s1 offen offset:2048 sc1
    ds_read_b128 v[88:91], v36 offset:12288
    ds_read_b128 v[92:95], v37 offset:12288
    ds_read_b128 v[96:99], v36 offset:14336
    ds_read_b128 v[100:103], v37 offset:14336
    ds_read_b64_tr_b16 v[110:111], v32 offset:12288
    ds_read_b64_tr_b16 v[118:119], v33 offset:12288
    ds_read_b64_tr_b16 v[126:127], v34 offset:12288
    ds_read_b64_tr_b16 v[134:135], v35 offset:12288
    ds_read_b64_tr_b16 v[142:143], v32 offset:14336
    ds_read_b64_tr_b16 v[150:151], v33 offset:14336
    ds_read_b64_tr_b16 v[158:159], v34 offset:14336
    ds_read_b64_tr_b16 v[166:167], v35 offset:14336
    s_branch L_sethint
L_notyet:
    ds_read_b128 v[88:91], v36 offset:12288
    ds_read_b128 v[92:95], v37 offset:12288
    ds_read_b128 v[96:99], v36 offset:14336
    ds_read_b128 v[100:103], v37 offset:14336
    ds_read_b64_tr_b16 v[110:111], v32 offset:12288
    ds_read_b64_tr_b16 v[118:119], v33 offset:12288
    ds_read_b64_tr_b16 v[126:127], v34 offset:12288
    ds_read_b64_tr_b16 v[134:135], v35 offset:12288
    ds_read_b64_tr_b16 v[142:143], v32 offset:14336
    ds_read_b64_tr_b16 v[150:151], v33 offset:14336
    ds_read_b64_tr_b16 v[158:159], v34 offset:14336
    ds_read_b64_tr_b16 v[166:167], v35 offset:14336
    s_mov_b32 s100, 0
L_qf:
    buffer_load_dword v26, v27, s[36:39], s61 offen sc1
    s_waitcnt vmcnt(0)
    v_cmp_ne_u32 vcc, s96, v26
    s_add_u32 s100, s100, 1
    s_cmp_gt_u32 s100, 48
    s_cbranch_scc1 L_qf_x
    s_and_b32 s20, vcc_lo, s63
    s_cbranch_scc0 L_qf_x
    s_sleep 1
    s_branch L_qf
L_qf_x:
    buffer_load_dwordx4 v[168:171], v39, s[36:39], s0 offen offset:0 sc1
    buffer_load_dwordx4 v[172:175], v39, s[36:39], s0 offen offset:1024 sc1
    buffer_load_dwordx4 v[176:179], v39, s[36:39], s0 offen offset:2048 sc1
    buffer_load_dwordx4 v[180:183], v39, s[36:39], s1 offen offset:0 sc1
    buffer_load_dwordx4 v[184:187], v39, s[36:39], s1 offen offset:1024 sc1
    buffer_load_dwordx4 v[188:191], v39, s[36:39], s1 offen offset:2048 sc1
L_sethint:
    s_cbranch_vccnz L_nosh
    v_mov_b32 v13, 0
    ds_write_b32 v13, v26 offset:1024
L_nosh:
    s_waitcnt vmcnt(0)
L_qgot:
    s_mov_b32 s100, 0
L_s2:
    v_cmp_ne_u32 s[52:53], s96, v171
    v_cmp_ne_u32 s[54:55], s96, v175
    v_cmp_ne_u32 s[56:57], s96, v179
    v_cmp_ne_u32 s[58:59], s96, v183
    v_cmp_ne_u32 s[14:15], s96, v187
    v_cmp_ne_u32 s[16:17], s96, v191
    s_or_b64 vcc, s[52:53], s[54:55]
    s_or_b64 vcc, vcc, s[56:57]
    s_or_b64 vcc, vcc, s[58:59]
    s_or_b64 vcc, vcc, s[14:15]
    s_or_b64 vcc, vcc, s[16:17]
    s_cbranch_scc0 L_qa_ok
    s_add_u32 s100, s100, 1
    s_cmp_gt_u32 s100, 262144
    s_cbranch_scc1 L_qa_ok
    s_sleep 2
    s_mov_b64 exec, s[52:53]
    s_cbranch_execz L_s2_0
    buffer_load_dwordx4 v[168:171], v39, s[36:39], s0 offen offset:0 sc1
L_s2_0:
    s_mov_b64 exec, s[54:55]
    s_cbranch_execz L_s2_1
    buffer_load_dwordx4 v[172:175], v39, s[36:39], s0 offen offset:1024 sc1
L_s2_1:
    s_mov_b64 exec, s[56:57]
    s_cbranch_execz L_s2_2
    buffer_load_dwordx4 v[176:179], v39, s[36:39], s0 offen offset:2048 sc1
L_s2_2:
    s_mov_b64 exec, s[58:59]
    s_cbranch_execz L_s2_3
    buffer_load_dwordx4 v[180:183], v39, s[36:39], s1 offen offset:0 sc1
L_s2_3:
    s_mov_b64 exec, s[14:15]
    s_cbranch_execz L_s2_4
    buffer_load_dwordx4 v[184:187], v39, s[36:39], s1 offen offset:1024 sc1
L_s2_4:
    s_mov_b64 exec, s[16:17]
    s_cbranch_execz L_s2_5
    buffer_load_dwordx4 v[188:191], v39, s[36:39], s1 offen offset:2048 sc1
L_s2_5:
    s_mov_b64 exec, -1
    s_waitcnt vmcnt(0)
    s_branch L_s2
L_qa_ok:
    v_mov_b32 v171, v176
    v_mov_b32 v175, v177
    v_mov_b32 v183, v188
    v_mov_b32 v187, v189
    s_waitcnt lgkmcnt(0)
    s_nop 0
    v_mfma_f32_16x16x32_bf16 v[192:195], v[40:43], v[168:171], 0
    v_mfma_f32_16x16x32_bf16 v[196:199], v[56:59], v[168:171], 0
    v_mfma_f32_16x16x32_bf16 v[200:203], v[72:75], v[168:171], 0
    v_mfma_f32_16x16x32_bf16 v[204:207], v[88:91], v[168:171], 0
    v_mfma_f32_16x16x32_bf16 v[192:195], v[44:47], v[172:175], v[192:195]
    v_mfma_f32_16x16x32_bf16 v[196:199], v[60:63], v[172:175], v[196:199]
    v_mfma_f32_16x16x32_bf16 v[200:203], v[76:79], v[172:175], v[200:203]
    v_mfma_f32_16x16x32_bf16 v[204:207], v[92:95], v[172:175], v[204:207]
    v_mfma_f32_16x16x32_bf16 v[192:195], v[48:51], v[180:183], v[192:195]
    v_mfma_f32_16x16x32_bf16 v[196:199], v[64:67], v[180:183], v[196:199]
    v_mfma_f32_16x16x32_bf16 v[200:203], v[80:83], v[180:183], v[200:203]
    v_mfma_f32_16x16x32_bf16 v[204:207], v[96:99], v[180:183], v[204:207]
    v_mfma_f32_16x16x32_bf16 v[192:195], v[52:55], v[184:187], v[192:195]
    v_mfma_f32_16x16x32_bf16 v[196:199], v[68:71], v[184:187], v[196:199]
    v_mfma_f32_16x16x32_bf16 v[200:203], v[84:87], v[184:187], v[200:203]
    v_mfma_f32_16x16x32_bf16 v[204:207], v[100:103], v[184:187], v[204:207]
    s_nop 4
    ds_write_b128 v216, v[192:195]
    ds_write_b128 v217, v[196:199]
    ds_write_b128 v218, v[200:203]
    ds_write_b128 v219, v[204:207]
    s_waitcnt lgkmcnt(0)
    s_barrier
    ds_read_b128 v[40:43], v220 offset:0
    ds_read_b128 v[44:47], v220 offset:16384
    ds_read_b128 v[48:51], v220 offset:32768
    ds_read_b128 v[52:55], v220 offset:49152
    s_lshl_b32 s21, s4, 4
    s_add_u32 s21, s21, s7
    s_lshl_b32 s21, s21, 8
    s_lshl_b32 s20, s3, 15
    s_add_u32 s20, s20, s21
    s_add_u32 s32, s20, 1048576
    s_add_u32 s20, s20, 4194304
    v_lshlrev_b32 v12, 18, v2
    v_lshl_add_u32 v12, v3, 4, v12
    v_lshlrev_b32 v13, 4, v2
    s_mov_b32 s33, 0x3db8aa3b
    s_waitcnt lgkmcnt(0)
    v_add_f32 v40, v40, v44
    v_add_f32 v48, v48, v52
    v_add_f32 v41, v41, v45
    v_add_f32 v49, v49, v53
    v_add_f32 v42, v42, v46
    v_add_f32 v50, v50, v54
    v_add_f32 v43, v43, v47
    v_add_f32 v51, v51, v55
    v_add_f32 v40, v40, v48
    v_add_f32 v41, v41, v49
    v_add_f32 v42, v42, v50
    v_add_f32 v43, v43, v51
    s_nop 0
    v_permlane32_swap_b32 v40, v42
    v_permlane32_swap_b32 v41, v43
    s_nop 0
    v_add_f32 v16, v40, v42
    v_add_f32 v17, v41, v43
    v_max_f32 v24, v16, v17
    s_nop 1
    v_max_f32_dpp v24, v24, v24 quad_perm:[1,0,3,2] row_mask:0xf bank_mask:0xf
    s_nop 1
    v_max_f32_dpp v24, v24, v24 quad_perm:[2,3,0,1] row_mask:0xf bank_mask:0xf
    s_nop 1
    v_max_f32_dpp v24, v24, v24 row_half_mirror row_mask:0xf bank_mask:0xf
    s_nop 1
    v_max_f32_dpp v24, v24, v24 row_mirror row_mask:0xf bank_mask:0xf
    v_mov_b32 v25, v24
    s_nop 1
    v_permlane32_swap_b32 v24, v25
    s_nop 0
    v_max_f32 v24, v24, v25
    v_mul_f32 v24, s33, v24
    v_fma_f32 v16, v16, s33, -v24
    v_fma_f32 v17, v17, s33, -v24
    v_exp_f32 v16, v16
    v_exp_f32 v17, v17
    s_nop 0
    v_cvt_pk_bf16_f32 v18, v16, v17
    v_add_f32 v25, v16, v17
    ds_write_b32 v221, v18 offset:2048
    s_nop 1
    v_add_f32_dpp v25, v25, v25 quad_perm:[1,0,3,2] row_mask:0xf bank_mask:0xf
    s_nop 1
    v_add_f32_dpp v25, v25, v25 quad_perm:[2,3,0,1] row_mask:0xf bank_mask:0xf
    s_nop 1
    v_add_f32_dpp v25, v25, v25 row_half_mirror row_mask:0xf bank_mask:0xf
    s_nop 1
    v_add_f32_dpp v25, v25, v25 row_mirror row_mask:0xf bank_mask:0xf
    v_mov_b32 v16, v25
    s_nop 1
    v_permlane32_swap_b32 v25, v16
    s_nop 0
    v_add_f32 v25, v25, v16
    ds_write_b64 v222, v[24:25] offset:1536
    s_waitcnt lgkmcnt(0)
    s_barrier
    ds_read_b128 v[208:211], v30 offset:2048
    ds_read_b128 v[212:215], v30 offset:3072
    ds_read_b64 v[24:25], v223 offset:1536
    v_mov_b32 v26, s96
    v_mov_b32 v27, s96
    s_waitcnt lgkmcnt(1)
    v_mfma_f32_16x16x32_bf16 v[40:43], v[104:107], v[208:211], 0
    v_mfma_f32_16x16x32_bf16 v[40:43], v[108:111], v[212:215], v[40:43]
    v_mfma_f32_16x16x32_bf16 v[44:47], v[112:115], v[208:211], 0
    v_mfma_f32_16x16x32_bf16 v[44:47], v[116:119], v[212:215], v[44:47]
    v_mfma_f32_16x16x32_bf16 v[48:51], v[120:123], v[208:211], 0
    v_mfma_f32_16x16x32_bf16 v[48:51], v[124:127], v[212:215], v[48:51]
    v_mfma_f32_16x16x32_bf16 v[52:55], v[128:131], v[208:211], 0
    v_mfma_f32_16x16x32_bf16 v[52:55], v[132:135], v[212:215], v[52:55]
    v_mfma_f32_16x16x32_bf16 v[56:59], v[136:139], v[208:211], 0
    v_mfma_f32_16x16x32_bf16 v[56:59], v[140:143], v[212:215], v[56:59]
    v_mfma_f32_16x16x32_bf16 v[60:63], v[144:147], v[208:211], 0
    v_mfma_f32_16x16x32_bf16 v[60:63], v[148:151], v[212:215], v[60:63]
    v_cvt_pk_bf16_f32 v168, v40, v41
    v_cvt_pk_bf16_f32 v169, v42, v43
    v_cvt_pk_bf16_f32 v170, v44, v45
    v_cvt_pk_bf16_f32 v171, v46, v47
    ds_write_b128 v216, v[168:171]
    v_mfma_f32_16x16x32_bf16 v[64:67], v[152:155], v[208:211], 0
    v_mfma_f32_16x16x32_bf16 v[64:67], v[156:159], v[212:215], v[64:67]
    s_nop 0
    v_cvt_pk_bf16_f32 v172, v48, v49
    v_cvt_pk_bf16_f32 v173, v50, v51
    v_cvt_pk_bf16_f32 v174, v52, v53
    v_cvt_pk_bf16_f32 v175, v54, v55
    ds_write_b128 v217, v[172:175]
    v_mfma_f32_16x16x32_bf16 v[68:71], v[160:163], v[208:211], 0
    v_mfma_f32_16x16x32_bf16 v[68:71], v[164:167], v[212:215], v[68:71]
    v_cvt_pk_bf16_f32 v176, v56, v57
    v_cvt_pk_bf16_f32 v177, v58, v59
    v_cvt_pk_bf16_f32 v178, v60, v61
    v_cvt_pk_bf16_f32 v179, v62, v63
    ds_write_b128 v218, v[176:179]
    s_nop 3
    v_cvt_pk_bf16_f32 v180, v64, v65
    v_cvt_pk_bf16_f32 v181, v66, v67
    v_cvt_pk_bf16_f32 v182, v68, v69
    v_cvt_pk_bf16_f32 v183, v70, v71
    ds_write_b128 v219, v[180:183]
    s_waitcnt lgkmcnt(0)
    ds_read_b128 v[104:107], v224 offset:0
    ds_read_b128 v[108:111], v225 offset:1024
    ds_read_b128 v[112:115], v226 offset:2048
    ds_read_b128 v[116:119], v227 offset:3072
    s_waitcnt lgkmcnt(3)
    buffer_store_dwordx4 v[104:107], v228, s[36:39], s20 offen sc1
    s_add_u32 s20, s20, 0x100000
    s_waitcnt lgkmcnt(2)
    buffer_store_dwordx4 v[108:111], v228, s[36:39], s20 offen sc1
    s_add_u32 s20, s20, 0x100000
    s_waitcnt lgkmcnt(1)
    buffer_store_dwordx4 v[112:115], v228, s[36:39], s20 offen sc1
    s_add_u32 s20, s20, 0x100000
    s_waitcnt lgkmcnt(0)
    buffer_store_dwordx4 v[116:119], v228, s[36:39], s20 offen sc1
    s_barrier
    s_mov_b64 exec, 0xffff
    s_waitcnt vmcnt(0)
    buffer_store_dwordx4 v[24:27], v13, s[36:39], s32 offen sc1
    s_mov_b64 exec, -1
    s_cmp_lg_u32 s3, 7
    s_cbranch_scc1 L_nogt
    s_lshl_b32 s20, s4, 7
    s_lshl_b32 s21, s7, 2
    s_add_u32 s20, s20, s21
    s_add_u32 s20, s20, 32768
    v_mov_b32 v13, 0
    s_mov_b64 exec, 1
    buffer_store_dword v26, v13, s[36:39], s20 offen
    s_mov_b64 exec, -1
L_nogt:

    s_cmp_ge_u32 s7, 14
    s_cbranch_scc1 L_final
    s_mov_b64 s[56:57], s[26:27]
    s_mov_b32 s58, 0x188000
    s_mov_b32 s59, 0x20000
    s_mov_b64 s[52:53], s[18:19]
    s_mov_b32 s54, 0x380000
    s_mov_b32 s55, 0x20000
    s_mov_b64 s[44:45], s[24:25]
    s_mov_b32 s46, 0xe00
    s_mov_b32 s47, 0x20000
    v_mul_u32_u24 v37, 896, v5
    v_add_u32 v37, v37, v4
    s_cmp_ge_u32 s7, 7
    s_cselect_b32 s101, 1, 0
    s_mul_i32 s21, s101, 7
    s_sub_u32 s98, s7, s21
    s_lshl_b32 s62, s4, 1
    s_add_u32 s62, s62, s101
    s_mul_i32 s0, s3, 7168
    s_lshl_b32 s21, s98, 7
    s_add_u32 s0, s0, s21
    s_mul_i32 s32, s62, 100352
    s_add_u32 s32, s32, s0
    s_mul_i32 s1, s62, 229376
    s_add_u32 s1, s1, s0
    s_lshl_b32 s33, s3, 10
    s_add_u32 s20, s32, 0
    s_add_u32 m0, s33, 36864
    s_nop 0
    buffer_load_dwordx4 v37, s[56:59], s20 offen nt lds
    s_add_u32 s20, s32, 57344
    s_add_u32 m0, s33, 45056
    s_nop 0
    buffer_load_dwordx4 v37, s[56:59], s20 offen nt lds
    s_mul_i32 s21, s62, 224
    s_and_b32 s63, s3, 1
    s_lshl_b32 s63, s63, 7
    s_add_u32 s21, s21, s63
    v_lshlrev_b32 v31, 1, v1
    buffer_load_ushort v29, v31, s[44:47], s21 offen
    v_add_u32 v31, s63, v31
    v_lshlrev_b32 v28, 3, v1
    v_mov_b32 v25, s96
    s_cmp_lt_u32 s3, 4
    s_cbranch_scc1 L_hdone
    s_cmp_ge_u32 s3, 6
    s_cbranch_scc1 L_hdone
    s_lshl_b32 s32, s4, 15
    s_mul_i32 s21, s101, 896
    s_add_u32 s32, s32, s21
    s_lshl_b32 s21, s63, 2
    s_add_u32 s32, s32, s21
    s_add_u32 s32, s32, 393216
    s_movk_i32 s21, 224
    v_cmp_gt_u32 s[26:27], s21, v31
    s_mov_b32 s100, 0
L_sh:
    s_mov_b32 s21, s32
    buffer_load_dwordx2 v[40:41], v28, s[36:39], s21 offen offset:0 sc1
    buffer_load_dwordx2 v[42:43], v28, s[36:39], s21 offen offset:2048 sc1
    s_add_u32 s21, s21, 4096
    buffer_load_dwordx2 v[44:45], v28, s[36:39], s21 offen offset:0 sc1
    buffer_load_dwordx2 v[46:47], v28, s[36:39], s21 offen offset:2048 sc1
    s_add_u32 s21, s21, 4096
    buffer_load_dwordx2 v[48:49], v28, s[36:39], s21 offen offset:0 sc1
    buffer_load_dwordx2 v[50:51], v28, s[36:39], s21 offen offset:2048 sc1
    s_add_u32 s21, s21, 4096
    buffer_load_dwordx2 v[52:53], v28, s[36:39], s21 offen offset:0 sc1
    buffer_load_dwordx2 v[54:55], v28, s[36:39], s21 offen offset:2048 sc1
    s_add_u32 s21, s21, 4096
    buffer_load_dwordx2 v[56:57], v28, s[36:39], s21 offen offset:0 sc1
    buffer_load_dwordx2 v[58:59], v28, s[36:39], s21 offen offset:2048 sc1
    s_add_u32 s21, s21, 4096
    buffer_load_dwordx2 v[60:61], v28, s[36:39], s21 offen offset:0 sc1
    buffer_load_dwordx2 v[62:63], v28, s[36:39], s21 offen offset:2048 sc1
    s_add_u32 s21, s21, 4096
    buffer_load_dwordx2 v[64:65], v28, s[36:39], s21 offen offset:0 sc1
    buffer_load_dwordx2 v[66:67], v28, s[36:39], s21 offen offset:2048 sc1
    s_add_u32 s21, s21, 4096
    s_waitcnt vmcnt(0)
    v_xor_b32 v16, s96, v41
    v_xor_b32 v17, s96, v43
    v_or_b32 v16, v16, v17
    v_xor_b32 v17, s96, v45
    v_or_b32 v16, v16, v17
    v_xor_b32 v17, s96, v47
    v_or_b32 v16, v16, v17
    v_xor_b32 v17, s96, v49
    v_or_b32 v16, v16, v17
    v_xor_b32 v17, s96, v51
    v_or_b32 v16, v16, v17
    v_xor_b32 v17, s96, v53
    v_or_b32 v16, v16, v17
    v_xor_b32 v17, s96, v55
    v_or_b32 v16, v16, v17
    v_xor_b32 v17, s96, v57
    v_or_b32 v16, v16, v17
    v_xor_b32 v17, s96, v59
    v_or_b32 v16, v16, v17
    v_xor_b32 v17, s96, v61
    v_or_b32 v16, v16, v17
    v_xor_b32 v17, s96, v63
    v_or_b32 v16, v16, v17
    v_xor_b32 v17, s96, v65
    v_or_b32 v16, v16, v17
    v_xor_b32 v17, s96, v67
    v_or_b32 v16, v16, v17
    v_cmp_ne_u32 vcc, 0, v16
    s_add_u32 s100, s100, 1
    s_cmp_gt_u32 s100, 262144
    s_cbranch_scc1 L_sh_x
    s_cbranch_vccnz L_sh

L_sh_x:
    v_add_f32 v16, v40, v42
    v_add_f32 v17, v44, v46
    v_add_f32 v16, v16, v48
    v_add_f32 v17, v17, v50
    v_add_f32 v16, v16, v52
    v_add_f32 v17, v17, v54
    v_add_f32 v16, v16, v56
    v_add_f32 v17, v17, v58
    v_add_f32 v16, v16, v60
    v_add_f32 v17, v17, v62
    v_add_f32 v16, v16, v64
    v_add_f32 v17, v17, v66
    v_add_f32 v16, v16, v17
    v_cvt_pk_bf16_f32 v16, v16, v16
    v_lshlrev_b32 v16, 16, v16
    v_lshlrev_b32 v29, 16, v29
    v_add_f32 v16, v16, v29
    v_cvt_pk_bf16_f32 v16, v16, v16
    v_lshlrev_b32 v16, 16, v16
    v_max_f32 v16, 0, v16
    v_mul_f32 v16, v16, v16
    v_cvt_pk_bf16_f32 v16, v16, v16
    v_cndmask_b32 v16, 0, v16, s[26:27]
    ds_write_b16 v31, v16 offset:512
L_hdone:
    s_add_u32 s20, s1, 0
    s_add_u32 m0, s33, 4096
    s_nop 0
    buffer_load_dwordx4 v37, s[52:55], s20 offen nt lds
    s_add_u32 s20, s1, 57344
    s_add_u32 m0, s33, 12288
    s_nop 0
    buffer_load_dwordx4 v37, s[52:55], s20 offen nt lds
    s_add_u32 s20, s1, 114688
    s_add_u32 m0, s33, 20480
    s_nop 0
    buffer_load_dwordx4 v37, s[52:55], s20 offen nt lds
    s_add_u32 s20, s1, 172032
    s_add_u32 m0, s33, 28672
    s_nop 0
    buffer_load_dwordx4 v37, s[52:55], s20 offen nt lds
    s_waitcnt vmcnt(4) lgkmcnt(0)
    s_barrier
    s_cmp_ge_u32 s3, 4
    s_cbranch_scc1 L_nof2
    ds_read_b64_tr_b16 v[160:161], v11 offset:36864
    ds_read_b64_tr_b16 v[162:163], v11 offset:38912
    ds_read_b64 v[40:41], v10 offset:512
    ds_read_b64 v[42:43], v10 offset:544
    ds_read_b64_tr_b16 v[164:165], v11 offset:40960
    ds_read_b64_tr_b16 v[166:167], v11 offset:43008
    ds_read_b64 v[44:45], v10 offset:576
    ds_read_b64 v[46:47], v10 offset:608
    ds_read_b64_tr_b16 v[168:169], v11 offset:45056
    ds_read_b64_tr_b16 v[170:171], v11 offset:47104
    ds_read_b64 v[48:49], v10 offset:640
    ds_read_b64 v[50:51], v10 offset:672
    ds_read_b64_tr_b16 v[172:173], v11 offset:49152
    ds_read_b64_tr_b16 v[174:175], v11 offset:51200
    ds_read_b64 v[52:53], v10 offset:704
    ds_read_b64 v[54:55], v10 offset:736
    s_lshl_b32 s20, s98, 4
    s_add_u32 s20, s20, s62
    s_lshl_b32 s20, s20, 9
    s_lshl_b32 s21, s3, 7
    s_add_u32 s20, s20, s21
    s_add_u32 s20, s20, 720896
    s_waitcnt lgkmcnt(0)
    v_mfma_f32_16x16x32_bf16 v[16:19], v[40:43], v[160:163], 0
    v_mfma_f32_16x16x32_bf16 v[16:19], v[44:47], v[164:167], v[16:19]
    v_mfma_f32_16x16x32_bf16 v[16:19], v[48:51], v[168:171], v[16:19]
    v_mfma_f32_16x16x32_bf16 v[16:19], v[52:55], v[172:175], v[16:19]
    s_mov_b64 exec, 0xffff
    s_nop 6
    v_mov_b32 v24, v16
    buffer_store_dwordx2 v[24:25], v28, s[36:39], s20 offen sc1
    s_mov_b64 exec, -1
L_nof2:
    s_lshr_b32 s32, s3, 2
    s_lshl_b32 s21, s32, 14
    v_add_u32 v12, s21, v11
    s_lshl_b32 s21, s32, 8
    v_add_u32 v14, s21, v10
    s_lshl_b32 s0, s62, 14
    s_lshl_b32 s21, s3, 8
    s_add_u32 s0, s0, s21
    s_add_u32 s1, s0, 2359296
    s_add_u32 s0, s0, 2097152
    v_and_b32 v13, 31, v1
    v_lshlrev_b32 v30, 1, v13
    s_lshl_b32 s21, s3, 6
    v_add_u32 v30, s21, v30
    v_lshlrev_b32 v13, 3, v13
    v_lshrrev_b32 v15, 5, v1
    v_lshl_add_u32 v13, v15, 13, v13
    s_lshl_b32 s33, s98, 4
    s_add_u32 s33, s33, s62
    s_lshl_b32 s33, s33, 1
    s_add_u32 s33, s33, s32
    s_lshl_b32 s33, s33, 9
    s_and_b32 s21, s3, 3
    s_lshl_b32 s21, s21, 7
    s_add_u32 s33, s33, s21
    s_add_u32 s33, s33, 3145728
    s_waitcnt vmcnt(0)
    s_barrier
    ds_read_b64_tr_b16 v[128:129], v12 offset:4096
    ds_read_b64_tr_b16 v[130:131], v12 offset:6144
    ds_read_b64_tr_b16 v[132:133], v12 offset:8192
    ds_read_b64_tr_b16 v[134:135], v12 offset:10240
    ds_read_b64_tr_b16 v[136:137], v12 offset:12288
    ds_read_b64_tr_b16 v[138:139], v12 offset:14336
    ds_read_b64_tr_b16 v[140:141], v12 offset:16384
    ds_read_b64_tr_b16 v[142:143], v12 offset:18432
    s_mov_b32 s100, 0
L_s4:
    s_and_b32 s21, s100, 33
    s_cmp_eq_u32 s21, 33
    s_cselect_b32 s20, s0, s1
    s_add_u32 s21, s20, 4096
    s_sleep 1
    buffer_load_dwordx2 v[16:17], v13, s[36:39], s20 offen offset:0 sc1
    buffer_load_dwordx2 v[18:19], v13, s[36:39], s20 offen offset:2048 sc1
    buffer_load_dwordx2 v[20:21], v13, s[36:39], s21 offen offset:0 sc1
    buffer_load_dwordx2 v[22:23], v13, s[36:39], s21 offen offset:2048 sc1
    s_waitcnt vmcnt(0)
    v_xor_b32 v26, s96, v17
    v_xor_b32 v27, s96, v19
    v_or_b32 v26, v26, v27
    v_xor_b32 v27, s96, v21
    v_or_b32 v26, v26, v27
    v_xor_b32 v27, s96, v23
    v_or_b32 v26, v26, v27
    v_cmp_ne_u32 vcc, 0, v26
    s_add_u32 s100, s100, 1
    s_cmp_gt_u32 s100, 262144
    s_cbranch_scc1 L_s4_x
    s_cbranch_vccnz L_s4

L_s4_x:
    v_add_f32 v16, v16, v18
    v_add_f32 v20, v20, v22
    v_add_f32 v16, v16, v20
    v_mov_b32 v17, v16
    s_nop 1
    v_permlane32_swap_b32 v16, v17
    s_nop 0
    v_add_f32 v16, v16, v17
    v_cvt_pk_bf16_f32 v16, v16, v16
    ds_write_b16 v30, v16 offset:1024
    s_waitcnt lgkmcnt(0)
    s_barrier
    ds_read_b64 v[40:41], v14 offset:1024
    ds_read_b64 v[42:43], v14 offset:1056
    ds_read_b64 v[44:45], v14 offset:1088
    ds_read_b64 v[46:47], v14 offset:1120
    ds_read_b64 v[48:49], v14 offset:1152
    ds_read_b64 v[50:51], v14 offset:1184
    ds_read_b64 v[52:53], v14 offset:1216
    ds_read_b64 v[54:55], v14 offset:1248
    s_waitcnt lgkmcnt(6)
    v_mfma_f32_16x16x32_bf16 v[16:19], v[40:43], v[128:131], 0
    s_waitcnt lgkmcnt(4)
    v_mfma_f32_16x16x32_bf16 v[16:19], v[44:47], v[132:135], v[16:19]
    s_waitcnt lgkmcnt(2)
    v_mfma_f32_16x16x32_bf16 v[16:19], v[48:51], v[136:139], v[16:19]
    s_waitcnt lgkmcnt(0)
    v_mfma_f32_16x16x32_bf16 v[16:19], v[52:55], v[140:143], v[16:19]
    s_mov_b64 exec, 0xffff
    s_nop 6
    v_mov_b32 v24, v16
    buffer_store_dwordx2 v[24:25], v28, s[36:39], s33 offen sc1
    s_mov_b64 exec, -1
    s_cmp_lg_u32 s3, 7
    s_cbranch_scc1 L_nog5
    s_lshl_b32 s20, s4, 10
    s_lshl_b32 s21, s7, 2
    s_add_u32 s20, s20, s21
    s_add_u32 s20, s20, 40960
    v_mov_b32 v13, 0
    s_mov_b64 exec, 1
    buffer_store_dword v25, v13, s[36:39], s20 offen
    s_mov_b64 exec, -1
L_nog5:

    s_endpgm
L_final:
    s_cmp_lg_u32 s7, 14
    s_cbranch_scc1 L_fin
    s_cmp_ge_u32 s3, 4
    s_cbranch_scc1 L_fin
    s_cmp_ge_u32 s4, 7
    s_cbranch_scc1 L_fin
    s_mov_b64 s[44:45], s[28:29]
    s_mov_b32 s46, 0x380
    s_mov_b32 s47, 0x20000
    s_mov_b64 s[48:49], s[30:31]
    s_mov_b32 s50, 0x380
    s_mov_b32 s51, 0x20000
    s_lshl_b32 s21, s3, 7
    s_lshl_b32 s20, s4, 13
    s_add_u32 s20, s20, s21
    s_add_u32 s20, s20, 720896
    s_add_u32 s0, s20, 4096
    s_lshl_b32 s33, s4, 14
    s_add_u32 s33, s33, s21
    s_add_u32 s33, s33, 3145728
    s_lshl_b32 s32, s4, 7
    s_lshl_b32 s21, s3, 5
    s_add_u32 s32, s32, s21
    v_and_b32 v15, 7, v1
    v_lshlrev_b32 v12, 9, v5
    v_lshl_add_u32 v12, v15, 4, v12
    v_lshlrev_b32 v15, 2, v15
    buffer_load_dword v40, v15, s[40:43], s32 offen
    buffer_load_dword v41, v15, s[44:47], s32 offen
    s_mov_b32 s100, 0
L_sf:
    s_sleep 2
    buffer_load_dwordx4 v[16:19], v12, s[36:39], s20 offen sc1
    buffer_load_dwordx4 v[20:23], v12, s[36:39], s0 offen sc1
    s_waitcnt vmcnt(0)
    v_xor_b32 v13, s96, v17
    v_xor_b32 v14, s96, v19
    v_or_b32 v13, v13, v14
    v_xor_b32 v14, s96, v21
    v_or_b32 v13, v13, v14
    v_xor_b32 v14, s96, v23
    v_or_b32 v13, v13, v14
    v_cmp_ne_u32 vcc, 0, v13
    s_add_u32 s100, s100, 1
    s_cmp_gt_u32 s100, 262144
    s_cbranch_scc1 L_sf_x
    s_cbranch_vccnz L_sf

L_sf_x:
    v_add_f32 v42, v16, v20
    v_add_f32 v43, v18, v22
    s_nop 1
    v_add_f32_dpp v42, v42, v42 row_ror:8 row_mask:0xf bank_mask:0xf
    v_mov_b32 v13, v42
    s_nop 1
    v_permlane16_swap_b32 v42, v13
    s_nop 1
    v_add_f32 v42, v42, v13
    v_mov_b32 v13, v42
    s_nop 1
    v_permlane32_swap_b32 v42, v13
    s_nop 1
    v_add_f32 v42, v42, v13
    s_nop 1
    v_add_f32_dpp v43, v43, v43 row_ror:8 row_mask:0xf bank_mask:0xf
    v_mov_b32 v13, v43
    s_nop 1
    v_permlane16_swap_b32 v43, v13
    s_nop 1
    v_add_f32 v43, v43, v13
    v_mov_b32 v13, v43
    s_nop 1
    v_permlane32_swap_b32 v43, v13
    s_nop 1
    v_add_f32 v43, v43, v13
    v_lshlrev_b32 v44, 16, v41
    v_and_b32 v45, 0xffff0000, v41
    v_cvt_pk_bf16_f32 v42, v42, v42
    v_lshlrev_b32 v42, 16, v42
    v_add_f32 v42, v42, v44
    v_cvt_pk_bf16_f32 v42, v42, v42
    v_lshlrev_b32 v42, 16, v42
    v_mul_f32 v13, 0xbfb8aa3b, v42
    v_exp_f32 v13, v13
    s_nop 0
    v_add_f32 v13, 1.0, v13
    v_rcp_f32 v13, v13
    s_nop 0
    v_mul_f32 v42, v42, v13

    v_cvt_pk_bf16_f32 v42, v42, v42
    v_lshlrev_b32 v42, 16, v42
    v_cvt_pk_bf16_f32 v43, v43, v43
    v_lshlrev_b32 v43, 16, v43
    v_add_f32 v43, v43, v45
    v_cvt_pk_bf16_f32 v43, v43, v43
    v_lshlrev_b32 v43, 16, v43
    v_mul_f32 v13, 0xbfb8aa3b, v43
    v_exp_f32 v13, v13
    s_nop 0
    v_add_f32 v13, 1.0, v13
    v_rcp_f32 v13, v13
    s_nop 0
    v_mul_f32 v43, v43, v13

    v_cvt_pk_bf16_f32 v43, v43, v43
    v_lshlrev_b32 v43, 16, v43
    v_lshlrev_b32 v44, 16, v40
    v_and_b32 v45, 0xffff0000, v40
    s_add_u32 s20, s33, 4096
    s_add_u32 s21, s33, 8192
    s_add_u32 s0, s33, 12288
    s_lshl_b32 s1, s4, 10
    s_add_u32 s1, s1, 40960
    v_lshlrev_b32 v13, 2, v2
    s_mov_b32 s100, 0
L_g5:
    buffer_load_dword v14, v13, s[36:39], s1 offen sc1
    s_waitcnt vmcnt(0)
    v_cmp_eq_u32 vcc, s96, v14
    s_add_u32 s100, s100, 1
    s_cmp_gt_u32 s100, 40
    s_cbranch_scc1 L_g5_x
    s_bcnt1_i32_b32 s62, vcc_lo
    s_cmp_ge_u32 s62, 16
    s_cbranch_scc0 L_g5
L_g5_x:

    s_mov_b32 s100, 0
L_s5:
    buffer_load_dwordx4 v[16:19], v12, s[36:39], s33 offen sc1
    buffer_load_dwordx4 v[20:23], v12, s[36:39], s20 offen sc1
    buffer_load_dwordx4 v[24:27], v12, s[36:39], s21 offen sc1
    buffer_load_dwordx4 v[28:31], v12, s[36:39], s0 offen sc1
    s_waitcnt vmcnt(0)
    v_xor_b32 v13, s96, v17
    v_xor_b32 v14, s96, v19
    v_or_b32 v13, v13, v14
    v_xor_b32 v14, s96, v21
    v_or_b32 v13, v13, v14
    v_xor_b32 v14, s96, v23
    v_or_b32 v13, v13, v14
    v_xor_b32 v14, s96, v25
    v_or_b32 v13, v13, v14
    v_xor_b32 v14, s96, v27
    v_or_b32 v13, v13, v14
    v_xor_b32 v14, s96, v29
    v_or_b32 v13, v13, v14
    v_xor_b32 v14, s96, v31
    v_or_b32 v13, v13, v14
    v_cmp_ne_u32 vcc, 0, v13
    s_add_u32 s100, s100, 1
    s_cmp_gt_u32 s100, 262144
    s_cbranch_scc1 L_s5_x
    s_cbranch_vccnz L_s5

L_s5_x:
    v_add_f32 v16, v16, v20
    v_add_f32 v24, v24, v28
    v_add_f32 v18, v18, v22
    v_add_f32 v26, v26, v30
    v_add_f32 v46, v16, v24
    v_add_f32 v47, v18, v26
    s_nop 1
    v_add_f32_dpp v46, v46, v46 row_ror:8 row_mask:0xf bank_mask:0xf
    v_mov_b32 v13, v46
    s_nop 1
    v_permlane16_swap_b32 v46, v13
    s_nop 1
    v_add_f32 v46, v46, v13
    v_mov_b32 v13, v46
    s_nop 1
    v_permlane32_swap_b32 v46, v13
    s_nop 1
    v_add_f32 v46, v46, v13
    s_nop 1
    v_add_f32_dpp v47, v47, v47 row_ror:8 row_mask:0xf bank_mask:0xf
    v_mov_b32 v13, v47
    s_nop 1
    v_permlane16_swap_b32 v47, v13
    s_nop 1
    v_add_f32 v47, v47, v13
    v_mov_b32 v13, v47
    s_nop 1
    v_permlane32_swap_b32 v47, v13
    s_nop 1
    v_add_f32 v47, v47, v13
    v_cvt_pk_bf16_f32 v46, v46, v46
    v_lshlrev_b32 v46, 16, v46
    v_mul_f32 v46, v46, v42
    v_cvt_pk_bf16_f32 v46, v46, v46
    v_lshlrev_b32 v46, 16, v46
    v_add_f32 v46, v46, v44
    v_cvt_pk_bf16_f32 v47, v47, v47
    v_lshlrev_b32 v47, 16, v47
    v_mul_f32 v47, v47, v43
    v_cvt_pk_bf16_f32 v47, v47, v47
    v_lshlrev_b32 v47, 16, v47
    v_add_f32 v47, v47, v45
    v_cvt_pk_bf16_f32 v46, v46, v47
    s_mov_b64 exec, 0xff
    buffer_store_dword v46, v15, s[48:51], s32 offen
    s_mov_b64 exec, -1
L_fin:
    s_endpgm
L_end:
    s_endpgm
.section .rodata,"a"
.p2align 6
.amdhsa_kernel recurrent_scan__compressed_kv_cla__dense_activation_squared_relu__decode_kernel
  .amdhsa_next_free_vgpr 256
  .amdhsa_next_free_sgpr 102
  .amdhsa_accum_offset 256
  .amdhsa_group_segment_fixed_size 0
  .amdhsa_kernarg_size 112
  .amdhsa_user_sgpr_count 2
  .amdhsa_user_sgpr_kernarg_segment_ptr 1
  .amdhsa_system_sgpr_workgroup_id_x 1
.end_amdhsa_kernel
```
